```python
import torch

def _softmax(x, axis=-1):
    return torch.softmax(x, dim=axis)
def _gelu(x):
    return torch.nn.functional.gelu(x, approximate="tanh")
def _silu(x):
    return torch.nn.functional.silu(x)
def _sigmoid(x):
    return torch.sigmoid(x)
def _layernorm(x, axis=-1, eps=1e-5):
    m = x.mean(dim=axis, keepdim=True)
    v = x.var(dim=axis, keepdim=True, unbiased=False)
    return (x - m) / torch.sqrt(v + eps)
def _scatter_add(tgt, idx, src, axis=0):
    return tgt.clone().index_add_(axis, idx, src)
def _segment_sum(src, seg, n):
    out = torch.zeros((n,) + src.shape[1:], dtype=src.dtype)
    return out.index_add_(0, seg, src)
def _pad(x, pw):
    flat = tuple(v for pair in reversed(pw) for v in pair)
    return torch.nn.functional.pad(x, flat)

kernel_name = 'standalone__depthwise_separable__vision'

def setup_inputs():

    _w = (lambda a: (lambda t: t.to(torch.bfloat16) if t.is_floating_point() else t)(torch.as_tensor(a)))
    H = W = 512
    C = 192
    k = 1
    return {
        "x": _w((lambda *s: torch.randn(*s, dtype=torch.bfloat16) * 0.05)(1, H, W, C)),
        "dw": _w((lambda *s: torch.randn(*s, dtype=torch.bfloat16) * 0.05)(k, k, C)),
        "pw": _w((lambda *s: torch.randn(*s, dtype=torch.bfloat16) * 0.05)(C, C)),
    }

def reference(x, dw, pw):
    B, H, W, C = x.shape
    k = dw.shape[0]
    pad = k // 2
    xp = _pad(x, ((0,0),(pad,pad),(pad,pad),(0,0)))
    out = torch.zeros_like(x)
    for i in range(k):
        for j in range(k):
            out = out + xp[:, i:i+H, j:j+W, :] * dw[i, j][None, None, None, :]
    return torch.einsum('bhwc,cd->bhwd', out, pw)
```

```asm
; @launch grid=(256,1,1) block=(256,1,1) lds=124928
.amdgcn_target "amdgcn-amd-amdhsa--gfx950"
.text
.globl standalone__depthwise_separable__vision_kernel
.p2align 8
.type standalone__depthwise_separable__vision_kernel,@function
standalone__depthwise_separable__vision_kernel:
    s_cmp_ge_u32 s2, 256
    s_cbranch_scc1 L_done
    s_load_dwordx8 s[4:11], s[0:1], 0
    s_load_dwordx4 s[36:39], s[0:1], 32
    s_getpc_b64 s[52:53]
L_pc:
    s_mov_b32 s54, L_done - L_pc
    s_mov_b32 s55, 0x00020000
    v_lshlrev_b32 v16, 4, v0
    buffer_load_dwordx4 v[208:211], v16, s[52:55], 0 offen
    v_add_u32 v16, 4096, v16
    buffer_load_dwordx4 v[212:215], v16, s[52:55], 0 offen
    v_add_u32 v16, 4096, v16
    buffer_load_dwordx4 v[216:219], v16, s[52:55], 0 offen
    v_add_u32 v16, 4096, v16
    buffer_load_dwordx4 v[220:223], v16, s[52:55], 0 offen
    v_and_b32 v12, 63, v0
    v_lshrrev_b32 v13, 6, v0
    v_lshrrev_b32 v15, 4, v12
    v_readfirstlane_b32 s28, v13
    v_lshlrev_b32 v9, 4, v15
    v_lshlrev_b32 v1, 4, v12
    v_add_u32 v2, 4096, v1
    v_and_b32 v13, 1, v13
    v_add_u32 v16, 0, v12
    v_mul_u32_u24 v17, 171, v16
    v_lshrrev_b32 v196, 12, v17
    v_mul_u32_u24 v18, 24, v196
    v_sub_u32 v200, v16, v18
    v_and_b32 v19, 2, v196
    v_lshl_or_b32 v19, v19, 1, v13
    v_xor_b32 v18, v200, v19
    v_mul_u32_u24 v17, 384, v196
    v_lshl_add_u32 v3, v18, 4, v17
    v_add_u32 v16, 64, v12
    v_mul_u32_u24 v17, 171, v16
    v_lshrrev_b32 v197, 12, v17
    v_mul_u32_u24 v18, 24, v197
    v_sub_u32 v201, v16, v18
    v_and_b32 v19, 2, v197
    v_lshl_or_b32 v19, v19, 1, v13
    v_xor_b32 v18, v201, v19
    v_mul_u32_u24 v17, 384, v197
    v_lshl_add_u32 v4, v18, 4, v17
    v_add_u32 v16, 128, v12
    v_mul_u32_u24 v17, 171, v16
    v_lshrrev_b32 v198, 12, v17
    v_mul_u32_u24 v18, 24, v198
    v_sub_u32 v202, v16, v18
    v_and_b32 v19, 2, v198
    v_lshl_or_b32 v19, v19, 1, v13
    v_xor_b32 v18, v202, v19
    v_mul_u32_u24 v17, 384, v198
    v_lshl_add_u32 v5, v18, 4, v17
    s_mov_b32 s26, 384
    s_mov_b32 s27, 0x00020000
    s_mov_b32 s22, 73728
    s_mov_b32 s23, 0x00020000
    s_mov_b32 s14, 100663296
    s_mov_b32 s15, 0x00020000
    s_lshr_b32 s29, s2, 3
    s_lshl_b32 s29, s29, 2
    s_and_b32 s30, s2, 7
    s_lshl_b32 s30, s30, 8
    s_add_u32 s30, s30, s28
    s_add_u32 s34, s30, s29
    s_mul_i32 s48, s34, 6144
    s_mul_i32 s32, s28, 3072
    s_mul_i32 s33, s28, 12800
    s_add_u32 s33, s33, 73728
    s_waitcnt lgkmcnt(0)
    s_mov_b32 s24, s6
    s_mov_b32 s25, s7
    s_mov_b32 s20, s8
    s_mov_b32 s21, s9
    s_mov_b32 s12, s4
    s_mov_b32 s13, s5
    buffer_load_dwordx4 v[20:23], v9, s[24:27], 0 offen offset:0
    buffer_load_dwordx4 v[24:27], v9, s[24:27], 0 offen offset:64
    buffer_load_dwordx4 v[28:31], v9, s[24:27], 0 offen offset:128
    buffer_load_dwordx4 v[32:35], v9, s[24:27], 0 offen offset:192
    buffer_load_dwordx4 v[36:39], v9, s[24:27], 0 offen offset:256
    buffer_load_dwordx4 v[40:43], v9, s[24:27], 0 offen offset:320
    s_add_u32 s34, s32, 0
    s_add_u32 m0, s34, 0
    s_nop 0
    buffer_load_dwordx4 v3, s[20:23], s34 offen lds
    s_add_u32 m0, s34, 1024
    s_nop 0
    buffer_load_dwordx4 v4, s[20:23], s34 offen lds
    s_add_u32 m0, s34, 2048
    s_nop 0
    buffer_load_dwordx4 v5, s[20:23], s34 offen lds
    s_add_u32 s34, s32, 12288
    s_add_u32 m0, s34, 0
    s_nop 0
    buffer_load_dwordx4 v3, s[20:23], s34 offen lds
    s_add_u32 m0, s34, 1024
    s_nop 0
    buffer_load_dwordx4 v4, s[20:23], s34 offen lds
    s_add_u32 m0, s34, 2048
    s_nop 0
    buffer_load_dwordx4 v5, s[20:23], s34 offen lds
    s_add_u32 m0, s33, 0
    s_nop 0
    buffer_load_dwordx4 v1, s[12:15], s48 offen offset:0 nt lds
    buffer_load_dwordx4 v1, s[12:15], s48 offen offset:1024 nt lds
    buffer_load_dwordx4 v1, s[12:15], s48 offen offset:2048 nt lds
    buffer_load_dwordx4 v1, s[12:15], s48 offen offset:3072 nt lds
    s_add_u32 m0, s33, 4096
    s_nop 0
    buffer_load_dwordx4 v2, s[12:15], s48 offen offset:0 nt lds
    buffer_load_dwordx4 v2, s[12:15], s48 offen offset:1024 nt lds
    s_add_u32 s34, s32, 24576
    s_add_u32 m0, s34, 0
    s_nop 0
    buffer_load_dwordx4 v3, s[20:23], s34 offen lds
    s_add_u32 m0, s34, 1024
    s_nop 0
    buffer_load_dwordx4 v4, s[20:23], s34 offen lds
    s_add_u32 m0, s34, 2048
    s_nop 0
    buffer_load_dwordx4 v5, s[20:23], s34 offen lds
    s_mov_b32 s16, s10
    s_mov_b32 s17, s11
    s_mov_b32 s18, 100663296
    s_mov_b32 s19, 0x00020000
    s_mov_b32 s40, s36
    s_mov_b32 s41, s37
    s_mov_b32 s42, 256
    s_mov_b32 s43, 0x00020000
    s_mov_b32 s44, s38
    s_mov_b32 s45, s39
    s_mov_b32 s46, 1052672
    s_mov_b32 s47, 0x00020000
    s_mov_b32 s31, 0xffff0000
    s_add_u32 s49, s48, 786432
    s_mov_b32 s50, 0
    s_mov_b32 s51, 16
    s_mov_b32 s56, 0xffff
    s_lshr_b32 s34, s2, 3
    s_and_b32 s35, s2, 7
    s_and_b32 s58, s34, 28
    s_lshr_b32 s59, s35, 1
    s_add_u32 s59, s59, s58
    s_lshl_b32 s57, s59, 7
    s_add_u32 s57, s57, 1048576
    s_lshl_b32 s61, 1, s59
    s_lshl_b32 s58, s58, 2
    s_lshl_b32 s68, s35, 8
    s_add_u32 s68, s68, s58
    s_xor_b32 s69, s68, 256
    s_and_b32 s70, s35, 1
    s_lshl_b32 s70, s70, 4
    s_lshl_b32 s71, 1, s70
    s_and_b32 s58, s2, 25
    s_or_b32 s58, s58, s28
    s_cmp_eq_u32 s58, 0
    s_cselect_b32 s62, 1, 0
    v_mov_b32 v10, 0
    v_mov_b32 v205, 0
    v_mov_b32 v11, 0
    v_and_b32 v14, 15, v12
    v_mul_u32_u24 v196, 400, v196
    v_lshl_add_u32 v196, v200, 4, v196
    v_mul_u32_u24 v197, 400, v197
    v_lshl_add_u32 v197, v201, 4, v197
    v_mul_u32_u24 v198, 400, v198
    v_lshl_add_u32 v198, v202, 4, v198
    v_lshrrev_b32 v16, 2, v14
    v_and_b32 v17, 3, v14
    v_lshl_add_u32 v18, v15, 3, v16
    v_mul_u32_u24 v18, 384, v18
    v_and_b32 v19, 1, v15
    v_xor_b32 v19, v19, v17
    v_lshl_add_u32 v18, v19, 4, v18
    v_and_b32 v19, 1, v17
    v_lshl_add_u32 v18, v19, 3, v18
    v_lshrrev_b32 v16, 1, v16
    v_lshlrev_b32 v16, 6, v16
    v_add_u32 v200, v18, v16
    v_sub_u32 v202, v18, v16
    v_xor_b32 v201, 8, v200
    v_xor_b32 v203, 8, v202
    v_mul_u32_u24 v6, 384, v14
    v_add3_u32 v6, v6, v9, s33
    v_mul_u32_u24 v7, 400, v14
    v_add3_u32 v7, v7, v9, s33
    v_and_b32 v19, 1, v15
    v_lshl_add_u32 v7, v19, 3, v7
    v_xor_b32 v8, 8, v7
    v_add_u32 v196, s33, v196
    v_add_u32 v197, s33, v197
    v_add_u32 v198, s33, v198
    s_waitcnt vmcnt(15)
    v_lshlrev_b32 v68, 16, v20
    v_and_b32 v69, s31, v20
    v_lshlrev_b32 v70, 16, v21
    v_and_b32 v71, s31, v21
    v_lshlrev_b32 v72, 16, v22
    v_and_b32 v73, s31, v22
    v_lshlrev_b32 v74, 16, v23
    v_and_b32 v75, s31, v23
    v_lshlrev_b32 v76, 16, v24
    v_and_b32 v77, s31, v24
    v_lshlrev_b32 v78, 16, v25
    v_and_b32 v79, s31, v25
    v_lshlrev_b32 v80, 16, v26
    v_and_b32 v81, s31, v26
    v_lshlrev_b32 v82, 16, v27
    v_and_b32 v83, s31, v27
    v_lshlrev_b32 v84, 16, v28
    v_and_b32 v85, s31, v28
    v_lshlrev_b32 v86, 16, v29
    v_and_b32 v87, s31, v29
    v_lshlrev_b32 v88, 16, v30
    v_and_b32 v89, s31, v30
    v_lshlrev_b32 v90, 16, v31
    v_and_b32 v91, s31, v31
    v_lshlrev_b32 v92, 16, v32
    v_and_b32 v93, s31, v32
    v_lshlrev_b32 v94, 16, v33
    v_and_b32 v95, s31, v33
    v_lshlrev_b32 v96, 16, v34
    v_and_b32 v97, s31, v34
    v_lshlrev_b32 v98, 16, v35
    v_and_b32 v99, s31, v35
    v_lshlrev_b32 v100, 16, v36
    v_and_b32 v101, s31, v36
    v_lshlrev_b32 v102, 16, v37
    v_and_b32 v103, s31, v37
    v_lshlrev_b32 v104, 16, v38
    v_and_b32 v105, s31, v38
    v_lshlrev_b32 v106, 16, v39
    v_and_b32 v107, s31, v39
    v_lshlrev_b32 v108, 16, v40
    v_and_b32 v109, s31, v40
    v_lshlrev_b32 v110, 16, v41
    v_and_b32 v111, s31, v41
    v_lshlrev_b32 v112, 16, v42
    v_and_b32 v113, s31, v42
    v_lshlrev_b32 v114, 16, v43
    v_and_b32 v115, s31, v43
    s_waitcnt vmcnt(12)
    s_barrier
    s_add_u32 s34, s32, 36864
    s_add_u32 m0, s34, 0
    s_nop 0
    buffer_load_dwordx4 v3, s[20:23], s34 offen lds
    s_add_u32 m0, s34, 1024
    s_nop 0
    buffer_load_dwordx4 v4, s[20:23], s34 offen lds
    s_add_u32 m0, s34, 2048
    s_nop 0
    buffer_load_dwordx4 v5, s[20:23], s34 offen lds
    s_add_u32 s34, s32, 49152
    s_add_u32 m0, s34, 0
    s_nop 0
    buffer_load_dwordx4 v3, s[20:23], s34 offen lds
    s_add_u32 m0, s34, 1024
    s_nop 0
    buffer_load_dwordx4 v4, s[20:23], s34 offen lds
    s_add_u32 m0, s34, 2048
    s_nop 0
    buffer_load_dwordx4 v5, s[20:23], s34 offen lds
    ds_read_b64_tr_b16 a[0:1], v200 offset:0
    ds_read_b64_tr_b16 a[2:3], v200 offset:1536
    ds_read_b64_tr_b16 a[4:5], v201 offset:0
    ds_read_b64_tr_b16 a[6:7], v201 offset:1536
    ds_read_b64_tr_b16 a[8:9], v202 offset:64
    ds_read_b64_tr_b16 a[10:11], v202 offset:1600
    ds_read_b64_tr_b16 a[12:13], v203 offset:64
    ds_read_b64_tr_b16 a[14:15], v203 offset:1600
    ds_read_b64_tr_b16 a[16:17], v200 offset:128
    ds_read_b64_tr_b16 a[18:19], v200 offset:1664
    ds_read_b64_tr_b16 a[20:21], v201 offset:128
    ds_read_b64_tr_b16 a[22:23], v201 offset:1664
    ds_read_b64_tr_b16 a[24:25], v202 offset:192
    ds_read_b64_tr_b16 a[26:27], v202 offset:1728
    ds_read_b64_tr_b16 a[28:29], v203 offset:192
    ds_read_b64_tr_b16 a[30:31], v203 offset:1728
    ds_read_b64_tr_b16 a[32:33], v200 offset:256
    ds_read_b64_tr_b16 a[34:35], v200 offset:1792
    ds_read_b64_tr_b16 a[36:37], v201 offset:256
    ds_read_b64_tr_b16 a[38:39], v201 offset:1792
    ds_read_b64_tr_b16 a[40:41], v202 offset:320
    ds_read_b64_tr_b16 a[42:43], v202 offset:1856
    ds_read_b64_tr_b16 a[44:45], v203 offset:320
    ds_read_b64_tr_b16 a[46:47], v203 offset:1856
    s_waitcnt vmcnt(9)
    ds_read_b128 v[116:119], v6 offset:0
    ds_read_b128 v[120:123], v6 offset:64
    ds_read_b128 v[124:127], v6 offset:128
    ds_read_b128 v[128:131], v6 offset:192
    ds_read_b128 v[132:135], v6 offset:256
    ds_read_b128 v[136:139], v6 offset:320
    s_waitcnt vmcnt(15)
    s_barrier
    s_add_u32 s34, s32, 61440
    s_add_u32 m0, s34, 0
    s_nop 0
    buffer_load_dwordx4 v3, s[20:23], s34 offen lds
    s_add_u32 m0, s34, 1024
    s_nop 0
    buffer_load_dwordx4 v4, s[20:23], s34 offen lds
    s_add_u32 m0, s34, 2048
    s_nop 0
    buffer_load_dwordx4 v5, s[20:23], s34 offen lds
    ds_read_b64_tr_b16 a[48:49], v200 offset:12288
    ds_read_b64_tr_b16 a[50:51], v200 offset:13824
    ds_read_b64_tr_b16 a[52:53], v201 offset:12288
    ds_read_b64_tr_b16 a[54:55], v201 offset:13824
    ds_read_b64_tr_b16 a[56:57], v202 offset:12352
    ds_read_b64_tr_b16 a[58:59], v202 offset:13888
    ds_read_b64_tr_b16 a[60:61], v203 offset:12352
    ds_read_b64_tr_b16 a[62:63], v203 offset:13888
    ds_read_b64_tr_b16 a[64:65], v200 offset:12416
    ds_read_b64_tr_b16 a[66:67], v200 offset:13952
    ds_read_b64_tr_b16 a[68:69], v201 offset:12416
    ds_read_b64_tr_b16 a[70:71], v201 offset:13952
    ds_read_b64_tr_b16 a[72:73], v202 offset:12480
    ds_read_b64_tr_b16 a[74:75], v202 offset:14016
    ds_read_b64_tr_b16 a[76:77], v203 offset:12480
    ds_read_b64_tr_b16 a[78:79], v203 offset:14016
    ds_read_b64_tr_b16 a[80:81], v200 offset:12544
    ds_read_b64_tr_b16 a[82:83], v200 offset:14080
    ds_read_b64_tr_b16 a[84:85], v201 offset:12544
    ds_read_b64_tr_b16 a[86:87], v201 offset:14080
    ds_read_b64_tr_b16 a[88:89], v202 offset:12608
    ds_read_b64_tr_b16 a[90:91], v202 offset:14144
    ds_read_b64_tr_b16 a[92:93], v203 offset:12608
    ds_read_b64_tr_b16 a[94:95], v203 offset:14144
    s_waitcnt lgkmcnt(15)
    v_lshlrev_b32 v12, 16, v116
    v_and_b32 v13, s31, v116
    v_lshlrev_b32 v14, 16, v117
    v_and_b32 v15, s31, v117
    v_mul_f32 v12, v12, v68
    v_mul_f32 v13, v13, v69
    v_lshlrev_b32 v16, 16, v118
    v_and_b32 v17, s31, v118
    v_mul_f32 v14, v14, v70
    v_mul_f32 v15, v15, v71
    v_cvt_pk_bf16_f32 v116, v12, v13
    v_lshlrev_b32 v18, 16, v119
    v_and_b32 v19, s31, v119
    v_mul_f32 v16, v16, v72
    v_mul_f32 v17, v17, v73
    v_cvt_pk_bf16_f32 v117, v14, v15
    v_mul_f32 v18, v18, v74
    v_mul_f32 v19, v19, v75
    v_cvt_pk_bf16_f32 v118, v16, v17
    v_cvt_pk_bf16_f32 v119, v18, v19
    s_nop 1
    s_waitcnt vmcnt(9)
    s_barrier
    s_cmp_eq_u32 s62, 1
    s_cselect_b32 s35, s57, 117440512
    s_mov_b64 exec, 1
    buffer_atomic_swap v205, v10, s[44:47], s35 offen sc0
    s_mov_b64 exec, -1
    s_add_u32 m0, s33, 6400
    s_nop 0
    buffer_load_dwordx4 v1, s[12:15], s49 offen offset:0 nt lds
    buffer_load_dwordx4 v1, s[12:15], s49 offen offset:1024 nt lds
    buffer_load_dwordx4 v1, s[12:15], s49 offen offset:2048 nt lds
    buffer_load_dwordx4 v1, s[12:15], s49 offen offset:3072 nt lds
    s_add_u32 m0, s33, 10496
    s_nop 0
    buffer_load_dwordx4 v2, s[12:15], s49 offen offset:0 nt lds
    buffer_load_dwordx4 v2, s[12:15], s49 offen offset:1024 nt lds
    v_mfma_f32_16x16x32_bf16 v[20:23], a[0:3], v[116:119], 0
    ds_read_b64_tr_b16 a[96:97], v200 offset:24576
    ds_read_b64_tr_b16 a[98:99], v200 offset:26112
    v_lshlrev_b32 v12, 16, v120
    v_and_b32 v13, s31, v120
    v_mfma_f32_16x16x32_bf16 v[24:27], a[4:7], v[116:119], 0
    ds_read_b64_tr_b16 a[100:101], v201 offset:24576
    ds_read_b64_tr_b16 a[102:103], v201 offset:26112
    v_lshlrev_b32 v14, 16, v121
    v_and_b32 v15, s31, v121
    v_mfma_f32_16x16x32_bf16 v[28:31], a[8:11], v[116:119], 0
    ds_read_b64_tr_b16 a[104:105], v202 offset:24640
    ds_read_b64_tr_b16 a[106:107], v202 offset:26176
    v_mul_f32 v12, v12, v76
    v_mul_f32 v13, v13, v77
    v_mfma_f32_16x16x32_bf16 v[32:35], a[12:15], v[116:119], 0
    ds_read_b64_tr_b16 a[108:109], v203 offset:24640
    ds_read_b64_tr_b16 a[110:111], v203 offset:26176
    v_lshlrev_b32 v16, 16, v122
    v_and_b32 v17, s31, v122
    v_mfma_f32_16x16x32_bf16 v[36:39], a[16:19], v[116:119], 0
    ds_read_b64_tr_b16 a[112:113], v200 offset:24704
    ds_read_b64_tr_b16 a[114:115], v200 offset:26240
    v_mul_f32 v14, v14, v78
    v_mul_f32 v15, v15, v79
    v_mfma_f32_16x16x32_bf16 v[40:43], a[20:23], v[116:119], 0
    ds_read_b64_tr_b16 a[116:117], v201 offset:24704
    ds_read_b64_tr_b16 a[118:119], v201 offset:26240
    v_cvt_pk_bf16_f32 v120, v12, v13
    v_lshlrev_b32 v18, 16, v123
    v_mfma_f32_16x16x32_bf16 v[44:47], a[24:27], v[116:119], 0
    ds_read_b64_tr_b16 a[120:121], v202 offset:24768
    ds_read_b64_tr_b16 a[122:123], v202 offset:26304
    v_and_b32 v19, s31, v123
    v_mul_f32 v16, v16, v80
    v_mfma_f32_16x16x32_bf16 v[48:51], a[28:31], v[116:119], 0
    ds_read_b64_tr_b16 a[124:125], v203 offset:24768
    ds_read_b64_tr_b16 a[126:127], v203 offset:26304
    v_mul_f32 v17, v17, v81
    v_cvt_pk_bf16_f32 v121, v14, v15
    v_mfma_f32_16x16x32_bf16 v[52:55], a[32:35], v[116:119], 0
    ds_read_b64_tr_b16 a[128:129], v200 offset:24832
    ds_read_b64_tr_b16 a[130:131], v200 offset:26368
    v_mul_f32 v18, v18, v82
    v_mul_f32 v19, v19, v83
    v_mfma_f32_16x16x32_bf16 v[56:59], a[36:39], v[116:119], 0
    ds_read_b64_tr_b16 a[132:133], v201 offset:24832
    ds_read_b64_tr_b16 a[134:135], v201 offset:26368
    v_cvt_pk_bf16_f32 v122, v16, v17
    v_cvt_pk_bf16_f32 v123, v18, v19
    v_mfma_f32_16x16x32_bf16 v[60:63], a[40:43], v[116:119], 0
    ds_read_b64_tr_b16 a[136:137], v202 offset:24896
    ds_read_b64_tr_b16 a[138:139], v202 offset:26432
    v_mfma_f32_16x16x32_bf16 v[64:67], a[44:47], v[116:119], 0
    ds_read_b64_tr_b16 a[140:141], v203 offset:24896
    ds_read_b64_tr_b16 a[142:143], v203 offset:26432
    s_waitcnt lgkmcnt(15)
    s_waitcnt vmcnt(13)
    s_barrier
    v_mfma_f32_16x16x32_bf16 v[20:23], a[48:51], v[120:123], v[20:23]
    ds_read_b64_tr_b16 a[144:145], v200 offset:36864
    ds_read_b64_tr_b16 a[146:147], v200 offset:38400
    v_lshlrev_b32 v12, 16, v124
    v_and_b32 v13, s31, v124
    v_mfma_f32_16x16x32_bf16 v[24:27], a[52:55], v[120:123], v[24:27]
    ds_read_b64_tr_b16 a[148:149], v201 offset:36864
    ds_read_b64_tr_b16 a[150:151], v201 offset:38400
    v_lshlrev_b32 v14, 16, v125
    v_and_b32 v15, s31, v125
    v_mfma_f32_16x16x32_bf16 v[28:31], a[56:59], v[120:123], v[28:31]
    ds_read_b64_tr_b16 a[152:153], v202 offset:36928
    ds_read_b64_tr_b16 a[154:155], v202 offset:38464
    v_mul_f32 v12, v12, v84
    v_mul_f32 v13, v13, v85
    v_mfma_f32_16x16x32_bf16 v[32:35], a[60:63], v[120:123], v[32:35]
    ds_read_b64_tr_b16 a[156:157], v203 offset:36928
    ds_read_b64_tr_b16 a[158:159], v203 offset:38464
    v_lshlrev_b32 v16, 16, v126
    v_and_b32 v17, s31, v126
    v_mfma_f32_16x16x32_bf16 v[36:39], a[64:67], v[120:123], v[36:39]
    ds_read_b64_tr_b16 a[160:161], v200 offset:36992
    ds_read_b64_tr_b16 a[162:163], v200 offset:38528
    v_mul_f32 v14, v14, v86
    v_mul_f32 v15, v15, v87
    v_mfma_f32_16x16x32_bf16 v[40:43], a[68:71], v[120:123], v[40:43]
    ds_read_b64_tr_b16 a[164:165], v201 offset:36992
    ds_read_b64_tr_b16 a[166:167], v201 offset:38528
    v_cvt_pk_bf16_f32 v124, v12, v13
    v_lshlrev_b32 v18, 16, v127
    v_mfma_f32_16x16x32_bf16 v[44:47], a[72:75], v[120:123], v[44:47]
    ds_read_b64_tr_b16 a[168:169], v202 offset:37056
    ds_read_b64_tr_b16 a[170:171], v202 offset:38592
    v_and_b32 v19, s31, v127
    v_mul_f32 v16, v16, v88
    v_mfma_f32_16x16x32_bf16 v[48:51], a[76:79], v[120:123], v[48:51]
    ds_read_b64_tr_b16 a[172:173], v203 offset:37056
    ds_read_b64_tr_b16 a[174:175], v203 offset:38592
    v_mul_f32 v17, v17, v89
    v_cvt_pk_bf16_f32 v125, v14, v15
    v_mfma_f32_16x16x32_bf16 v[52:55], a[80:83], v[120:123], v[52:55]
    ds_read_b64_tr_b16 a[176:177], v200 offset:37120
    ds_read_b64_tr_b16 a[178:179], v200 offset:38656
    v_mul_f32 v18, v18, v90
    v_mul_f32 v19, v19, v91
    v_mfma_f32_16x16x32_bf16 v[56:59], a[84:87], v[120:123], v[56:59]
    ds_read_b64_tr_b16 a[180:181], v201 offset:37120
    ds_read_b64_tr_b16 a[182:183], v201 offset:38656
    v_cvt_pk_bf16_f32 v126, v16, v17
    v_cvt_pk_bf16_f32 v127, v18, v19
    v_mfma_f32_16x16x32_bf16 v[60:63], a[88:91], v[120:123], v[60:63]
    ds_read_b64_tr_b16 a[184:185], v202 offset:37184
    ds_read_b64_tr_b16 a[186:187], v202 offset:38720
    v_mfma_f32_16x16x32_bf16 v[64:67], a[92:95], v[120:123], v[64:67]
    ds_read_b64_tr_b16 a[188:189], v203 offset:37184
    ds_read_b64_tr_b16 a[190:191], v203 offset:38720
    s_waitcnt lgkmcnt(15)
    s_waitcnt vmcnt(10)
    s_barrier
    v_mfma_f32_16x16x32_bf16 v[20:23], a[96:99], v[124:127], v[20:23]
    ds_read_b64_tr_b16 a[192:193], v200 offset:49152
    ds_read_b64_tr_b16 a[194:195], v200 offset:50688
    v_lshlrev_b32 v12, 16, v128
    v_and_b32 v13, s31, v128
    v_mfma_f32_16x16x32_bf16 v[24:27], a[100:103], v[124:127], v[24:27]
    ds_read_b64_tr_b16 a[196:197], v201 offset:49152
    ds_read_b64_tr_b16 a[198:199], v201 offset:50688
    v_lshlrev_b32 v14, 16, v129
    v_and_b32 v15, s31, v129
    v_mfma_f32_16x16x32_bf16 v[28:31], a[104:107], v[124:127], v[28:31]
    ds_read_b64_tr_b16 a[200:201], v202 offset:49216
    ds_read_b64_tr_b16 a[202:203], v202 offset:50752
    v_mul_f32 v12, v12, v92
    v_mul_f32 v13, v13, v93
    v_mfma_f32_16x16x32_bf16 v[32:35], a[108:111], v[124:127], v[32:35]
    ds_read_b64_tr_b16 a[204:205], v203 offset:49216
    ds_read_b64_tr_b16 a[206:207], v203 offset:50752
    v_lshlrev_b32 v16, 16, v130
    v_and_b32 v17, s31, v130
    v_mfma_f32_16x16x32_bf16 v[36:39], a[112:115], v[124:127], v[36:39]
    ds_read_b64_tr_b16 a[208:209], v200 offset:49280
    ds_read_b64_tr_b16 a[210:211], v200 offset:50816
    v_mul_f32 v14, v14, v94
    v_mul_f32 v15, v15, v95
    v_mfma_f32_16x16x32_bf16 v[40:43], a[116:119], v[124:127], v[40:43]
    ds_read_b64_tr_b16 a[212:213], v201 offset:49280
    ds_read_b64_tr_b16 a[214:215], v201 offset:50816
    v_cvt_pk_bf16_f32 v128, v12, v13
    v_lshlrev_b32 v18, 16, v131
    v_mfma_f32_16x16x32_bf16 v[44:47], a[120:123], v[124:127], v[44:47]
    ds_read_b64_tr_b16 a[216:217], v202 offset:49344
    ds_read_b64_tr_b16 a[218:219], v202 offset:50880
    v_and_b32 v19, s31, v131
    v_mul_f32 v16, v16, v96
    v_mfma_f32_16x16x32_bf16 v[48:51], a[124:127], v[124:127], v[48:51]
    ds_read_b64_tr_b16 a[220:221], v203 offset:49344
    ds_read_b64_tr_b16 a[222:223], v203 offset:50880
    v_mul_f32 v17, v17, v97
    v_cvt_pk_bf16_f32 v129, v14, v15
    v_mfma_f32_16x16x32_bf16 v[52:55], a[128:131], v[124:127], v[52:55]
    ds_read_b64_tr_b16 a[224:225], v200 offset:49408
    ds_read_b64_tr_b16 a[226:227], v200 offset:50944
    v_mul_f32 v18, v18, v98
    v_mul_f32 v19, v19, v99
    v_mfma_f32_16x16x32_bf16 v[56:59], a[132:135], v[124:127], v[56:59]
    ds_read_b64_tr_b16 a[228:229], v201 offset:49408
    ds_read_b64_tr_b16 a[230:231], v201 offset:50944
    v_cvt_pk_bf16_f32 v130, v16, v17
    v_cvt_pk_bf16_f32 v131, v18, v19
    v_mfma_f32_16x16x32_bf16 v[60:63], a[136:139], v[124:127], v[60:63]
    ds_read_b64_tr_b16 a[232:233], v202 offset:49472
    ds_read_b64_tr_b16 a[234:235], v202 offset:51008
    v_mfma_f32_16x16x32_bf16 v[64:67], a[140:143], v[124:127], v[64:67]
    ds_read_b64_tr_b16 a[236:237], v203 offset:49472
    ds_read_b64_tr_b16 a[238:239], v203 offset:51008
    s_waitcnt lgkmcnt(15)
    s_waitcnt vmcnt(7)
    s_barrier
    v_mfma_f32_16x16x32_bf16 v[20:23], a[144:147], v[128:131], v[20:23]
    ds_read_b64_tr_b16 a[240:241], v200 offset:61440
    ds_read_b64_tr_b16 a[242:243], v200 offset:62976
    v_lshlrev_b32 v12, 16, v132
    v_and_b32 v13, s31, v132
    v_mfma_f32_16x16x32_bf16 v[24:27], a[148:151], v[128:131], v[24:27]
    ds_read_b64_tr_b16 a[244:245], v201 offset:61440
    ds_read_b64_tr_b16 a[246:247], v201 offset:62976
    v_lshlrev_b32 v14, 16, v133
    v_and_b32 v15, s31, v133
    v_mfma_f32_16x16x32_bf16 v[28:31], a[152:155], v[128:131], v[28:31]
    ds_read_b64_tr_b16 a[248:249], v202 offset:61504
    ds_read_b64_tr_b16 a[250:251], v202 offset:63040
    v_mul_f32 v12, v12, v100
    v_mul_f32 v13, v13, v101
    v_mfma_f32_16x16x32_bf16 v[32:35], a[156:159], v[128:131], v[32:35]
    ds_read_b64_tr_b16 a[252:253], v203 offset:61504
    ds_read_b64_tr_b16 a[254:255], v203 offset:63040
    v_lshlrev_b32 v16, 16, v134
    v_and_b32 v17, s31, v134
    v_mfma_f32_16x16x32_bf16 v[36:39], a[160:163], v[128:131], v[36:39]
    ds_read_b64_tr_b16 v[164:165], v200 offset:61568
    ds_read_b64_tr_b16 v[166:167], v200 offset:63104
    v_mul_f32 v14, v14, v102
    v_mul_f32 v15, v15, v103
    v_mfma_f32_16x16x32_bf16 v[40:43], a[164:167], v[128:131], v[40:43]
    ds_read_b64_tr_b16 v[168:169], v201 offset:61568
    ds_read_b64_tr_b16 v[170:171], v201 offset:63104
    v_cvt_pk_bf16_f32 v132, v12, v13
    v_lshlrev_b32 v18, 16, v135
    v_mfma_f32_16x16x32_bf16 v[44:47], a[168:171], v[128:131], v[44:47]
    ds_read_b64_tr_b16 v[172:173], v202 offset:61632
    ds_read_b64_tr_b16 v[174:175], v202 offset:63168
    v_and_b32 v19, s31, v135
    v_mul_f32 v16, v16, v104
    v_mfma_f32_16x16x32_bf16 v[48:51], a[172:175], v[128:131], v[48:51]
    ds_read_b64_tr_b16 v[176:177], v203 offset:61632
    ds_read_b64_tr_b16 v[178:179], v203 offset:63168
    v_mul_f32 v17, v17, v105
    v_cvt_pk_bf16_f32 v133, v14, v15
    v_mfma_f32_16x16x32_bf16 v[52:55], a[176:179], v[128:131], v[52:55]
    ds_read_b64_tr_b16 v[180:181], v200 offset:61696
    ds_read_b64_tr_b16 v[182:183], v200 offset:63232
    v_mul_f32 v18, v18, v106
    v_mul_f32 v19, v19, v107
    v_mfma_f32_16x16x32_bf16 v[56:59], a[180:183], v[128:131], v[56:59]
    ds_read_b64_tr_b16 v[184:185], v201 offset:61696
    ds_read_b64_tr_b16 v[186:187], v201 offset:63232
    v_cvt_pk_bf16_f32 v134, v16, v17
    v_cvt_pk_bf16_f32 v135, v18, v19
    v_mfma_f32_16x16x32_bf16 v[60:63], a[184:187], v[128:131], v[60:63]
    ds_read_b64_tr_b16 v[188:189], v202 offset:61760
    ds_read_b64_tr_b16 v[190:191], v202 offset:63296
    v_mfma_f32_16x16x32_bf16 v[64:67], a[188:191], v[128:131], v[64:67]
    ds_read_b64_tr_b16 v[192:193], v203 offset:61760
    ds_read_b64_tr_b16 v[194:195], v203 offset:63296
    s_waitcnt lgkmcnt(15)
    v_mfma_f32_16x16x32_bf16 v[20:23], a[192:195], v[132:135], v[20:23]
    v_lshlrev_b32 v12, 16, v136
    v_and_b32 v13, s31, v136
    v_mfma_f32_16x16x32_bf16 v[24:27], a[196:199], v[132:135], v[24:27]
    v_lshlrev_b32 v14, 16, v137
    v_and_b32 v15, s31, v137
    v_mfma_f32_16x16x32_bf16 v[28:31], a[200:203], v[132:135], v[28:31]
    v_mul_f32 v12, v12, v108
    v_mul_f32 v13, v13, v109
    v_mfma_f32_16x16x32_bf16 v[32:35], a[204:207], v[132:135], v[32:35]
    v_lshlrev_b32 v16, 16, v138
    v_and_b32 v17, s31, v138
    v_mfma_f32_16x16x32_bf16 v[36:39], a[208:211], v[132:135], v[36:39]
    v_mul_f32 v14, v14, v110
    v_mul_f32 v15, v15, v111
    v_mfma_f32_16x16x32_bf16 v[40:43], a[212:215], v[132:135], v[40:43]
    v_cvt_pk_bf16_f32 v136, v12, v13
    v_lshlrev_b32 v18, 16, v139
    v_mfma_f32_16x16x32_bf16 v[44:47], a[216:219], v[132:135], v[44:47]
    v_and_b32 v19, s31, v139
    v_mul_f32 v16, v16, v112
    v_mfma_f32_16x16x32_bf16 v[48:51], a[220:223], v[132:135], v[48:51]
    v_mul_f32 v17, v17, v113
    v_cvt_pk_bf16_f32 v137, v14, v15
    v_mfma_f32_16x16x32_bf16 v[52:55], a[224:227], v[132:135], v[52:55]
    v_mul_f32 v18, v18, v114
    v_mul_f32 v19, v19, v115
    v_mfma_f32_16x16x32_bf16 v[56:59], a[228:231], v[132:135], v[56:59]
    v_cvt_pk_bf16_f32 v138, v16, v17
    v_cvt_pk_bf16_f32 v139, v18, v19
    v_mfma_f32_16x16x32_bf16 v[60:63], a[232:235], v[132:135], v[60:63]
    v_mfma_f32_16x16x32_bf16 v[64:67], a[236:239], v[132:135], v[64:67]
    s_waitcnt lgkmcnt(0)
    v_mfma_f32_16x16x32_bf16 v[20:23], a[240:243], v[136:139], v[20:23]
    v_mfma_f32_16x16x32_bf16 v[24:27], a[244:247], v[136:139], v[24:27]
    v_mfma_f32_16x16x32_bf16 v[28:31], a[248:251], v[136:139], v[28:31]
    v_mfma_f32_16x16x32_bf16 v[32:35], a[252:255], v[136:139], v[32:35]
    v_mfma_f32_16x16x32_bf16 v[36:39], v[164:167], v[136:139], v[36:39]
    v_mfma_f32_16x16x32_bf16 v[40:43], v[168:171], v[136:139], v[40:43]
    v_mfma_f32_16x16x32_bf16 v[44:47], v[172:175], v[136:139], v[44:47]
    v_mfma_f32_16x16x32_bf16 v[48:51], v[176:179], v[136:139], v[48:51]
    v_mfma_f32_16x16x32_bf16 v[52:55], v[180:183], v[136:139], v[52:55]
    v_mfma_f32_16x16x32_bf16 v[56:59], v[184:187], v[136:139], v[56:59]
    v_mfma_f32_16x16x32_bf16 v[60:63], v[188:191], v[136:139], v[60:63]
    v_mfma_f32_16x16x32_bf16 v[64:67], v[192:195], v[136:139], v[64:67]
    v_cvt_pk_bf16_f32 v140, v20, v21
    v_cvt_pk_bf16_f32 v141, v22, v23
    v_cvt_pk_bf16_f32 v142, v24, v25
    v_cvt_pk_bf16_f32 v143, v26, v27
    ds_write_b64 v7, v[140:141] offset:0
    ds_write_b64 v8, v[142:143] offset:0
    v_cvt_pk_bf16_f32 v144, v28, v29
    v_cvt_pk_bf16_f32 v145, v30, v31
    v_cvt_pk_bf16_f32 v146, v32, v33
    v_cvt_pk_bf16_f32 v147, v34, v35
    ds_write_b64 v7, v[144:145] offset:64
    ds_write_b64 v8, v[146:147] offset:64
    v_cvt_pk_bf16_f32 v148, v36, v37
    v_cvt_pk_bf16_f32 v149, v38, v39
    v_cvt_pk_bf16_f32 v150, v40, v41
    v_cvt_pk_bf16_f32 v151, v42, v43
    ds_write_b64 v7, v[148:149] offset:128
    ds_write_b64 v8, v[150:151] offset:128
    v_cvt_pk_bf16_f32 v152, v44, v45
    v_cvt_pk_bf16_f32 v153, v46, v47
    v_cvt_pk_bf16_f32 v154, v48, v49
    v_cvt_pk_bf16_f32 v155, v50, v51
    ds_write_b64 v7, v[152:153] offset:192
    ds_write_b64 v8, v[154:155] offset:192
    v_cvt_pk_bf16_f32 v156, v52, v53
    v_cvt_pk_bf16_f32 v157, v54, v55
    v_cvt_pk_bf16_f32 v158, v56, v57
    v_cvt_pk_bf16_f32 v159, v58, v59
    ds_write_b64 v7, v[156:157] offset:256
    ds_write_b64 v8, v[158:159] offset:256
    v_cvt_pk_bf16_f32 v160, v60, v61
    v_cvt_pk_bf16_f32 v161, v62, v63
    v_cvt_pk_bf16_f32 v162, v64, v65
    v_cvt_pk_bf16_f32 v163, v66, v67
    ds_write_b64 v7, v[160:161] offset:320
    ds_write_b64 v8, v[162:163] offset:320
    ds_read_b128 v[140:143], v196 offset:0
    ds_read_b128 v[144:147], v197 offset:0
    ds_read_b128 v[148:151], v198 offset:0
    ds_read_b128 v[152:155], v196 offset:3200
    ds_read_b128 v[156:159], v197 offset:3200
    ds_read_b128 v[160:163], v198 offset:3200
    s_cmp_lg_u32 s50, 1
    s_cbranch_scc1 L_no_t0
    s_cmp_lg_u32 s62, 1
    s_cbranch_scc1 L_no_t0
    s_mov_b64 exec, 1
    v_mov_b32 v205, s61
    buffer_atomic_or v205, v10, s[40:43], 0 offen
    s_mov_b64 exec, -1
L_no_t0:
    s_add_u32 s59, s50, 2
    s_mov_b32 s35, s30
    s_waitcnt lgkmcnt(5)
    buffer_store_dwordx4 v[140:143], v1, s[16:19], s48 offen offset:0 sc1
    s_lshr_b32 s34, s59, 1
    s_lshl_b32 s34, s34, 11
    s_waitcnt lgkmcnt(4)
    buffer_store_dwordx4 v[144:147], v1, s[16:19], s48 offen offset:1024 sc1
    s_and_b32 s58, s59, 1
    s_lshl_b32 s58, s58, 7
    s_waitcnt lgkmcnt(3)
    buffer_store_dwordx4 v[148:151], v1, s[16:19], s48 offen offset:2048 sc1
    s_add_u32 s34, s34, s58
    s_add_u32 s34, s34, s35
    s_waitcnt lgkmcnt(2)
    buffer_store_dwordx4 v[152:155], v1, s[16:19], s48 offen offset:3072 sc1
    s_add_u32 s34, s34, s29
    s_mul_i32 s34, s34, 6144
    s_waitcnt lgkmcnt(1)
    buffer_store_dwordx4 v[156:159], v2, s[16:19], s48 offen offset:0 sc1
    s_cmp_lt_u32 s59, 16
    s_cselect_b32 s58, s34, 117440512
    s_waitcnt lgkmcnt(0)
    buffer_store_dwordx4 v[160:163], v2, s[16:19], s48 offen offset:1024 sc1
    s_mov_b32 s48, s58
    s_add_u32 s50, s50, 1
    s_add_u32 m0, s33, 0
    s_nop 0
    buffer_load_dwordx4 v1, s[12:15], s48 offen offset:0 nt lds
    buffer_load_dwordx4 v1, s[12:15], s48 offen offset:1024 nt lds
    buffer_load_dwordx4 v1, s[12:15], s48 offen offset:2048 nt lds
    buffer_load_dwordx4 v1, s[12:15], s48 offen offset:3072 nt lds
    s_add_u32 m0, s33, 4096
    s_nop 0
    buffer_load_dwordx4 v2, s[12:15], s48 offen offset:0 nt lds
    buffer_load_dwordx4 v2, s[12:15], s48 offen offset:1024 nt lds
L_sloop:
    s_waitcnt vmcnt(12)
    ds_read_b128 v[116:119], v6 offset:6400
    ds_read_b128 v[120:123], v6 offset:6464
    ds_read_b128 v[124:127], v6 offset:6528
    ds_read_b128 v[128:131], v6 offset:6592
    ds_read_b128 v[132:135], v6 offset:6656
    ds_read_b128 v[136:139], v6 offset:6720
    s_waitcnt lgkmcnt(5)
    v_lshlrev_b32 v12, 16, v116
    v_and_b32 v13, s31, v116
    v_lshlrev_b32 v14, 16, v117
    v_and_b32 v15, s31, v117
    v_mul_f32 v12, v12, v68
    v_mul_f32 v13, v13, v69
    v_lshlrev_b32 v16, 16, v118
    v_and_b32 v17, s31, v118
    v_mul_f32 v14, v14, v70
    v_mul_f32 v15, v15, v71
    v_cvt_pk_bf16_f32 v116, v12, v13
    v_lshlrev_b32 v18, 16, v119
    v_and_b32 v19, s31, v119
    v_mul_f32 v16, v16, v72
    v_mul_f32 v17, v17, v73
    v_cvt_pk_bf16_f32 v117, v14, v15
    v_mul_f32 v18, v18, v74
    v_mul_f32 v19, v19, v75
    v_cvt_pk_bf16_f32 v118, v16, v17
    v_cvt_pk_bf16_f32 v119, v18, v19
    s_nop 1
    s_waitcnt lgkmcnt(4)
    v_mfma_f32_16x16x32_bf16 v[20:23], a[0:3], v[116:119], 0
    v_lshlrev_b32 v12, 16, v120
    v_and_b32 v13, s31, v120
    v_mfma_f32_16x16x32_bf16 v[24:27], a[4:7], v[116:119], 0
    v_lshlrev_b32 v14, 16, v121
    v_and_b32 v15, s31, v121
    v_mfma_f32_16x16x32_bf16 v[28:31], a[8:11], v[116:119], 0
    v_mul_f32 v12, v12, v76
    v_mul_f32 v13, v13, v77
    v_mfma_f32_16x16x32_bf16 v[32:35], a[12:15], v[116:119], 0
    v_lshlrev_b32 v16, 16, v122
    v_and_b32 v17, s31, v122
    v_mfma_f32_16x16x32_bf16 v[36:39], a[16:19], v[116:119], 0
    v_mul_f32 v14, v14, v78
    v_mul_f32 v15, v15, v79
    v_mfma_f32_16x16x32_bf16 v[40:43], a[20:23], v[116:119], 0
    v_cvt_pk_bf16_f32 v120, v12, v13
    v_lshlrev_b32 v18, 16, v123
    v_mfma_f32_16x16x32_bf16 v[44:47], a[24:27], v[116:119], 0
    v_and_b32 v19, s31, v123
    v_mul_f32 v16, v16, v80
    v_mfma_f32_16x16x32_bf16 v[48:51], a[28:31], v[116:119], 0
    v_mul_f32 v17, v17, v81
    v_cvt_pk_bf16_f32 v121, v14, v15
    v_mfma_f32_16x16x32_bf16 v[52:55], a[32:35], v[116:119], 0
    v_mul_f32 v18, v18, v82
    v_mul_f32 v19, v19, v83
    v_mfma_f32_16x16x32_bf16 v[56:59], a[36:39], v[116:119], 0
    v_cvt_pk_bf16_f32 v122, v16, v17
    v_cvt_pk_bf16_f32 v123, v18, v19
    v_mfma_f32_16x16x32_bf16 v[60:63], a[40:43], v[116:119], 0
    v_mfma_f32_16x16x32_bf16 v[64:67], a[44:47], v[116:119], 0
    s_waitcnt lgkmcnt(3)
    v_mfma_f32_16x16x32_bf16 v[20:23], a[48:51], v[120:123], v[20:23]
    v_lshlrev_b32 v12, 16, v124
    v_and_b32 v13, s31, v124
    v_mfma_f32_16x16x32_bf16 v[24:27], a[52:55], v[120:123], v[24:27]
    v_lshlrev_b32 v14, 16, v125
    v_and_b32 v15, s31, v125
    v_mfma_f32_16x16x32_bf16 v[28:31], a[56:59], v[120:123], v[28:31]
    v_mul_f32 v12, v12, v84
    v_mul_f32 v13, v13, v85
    v_mfma_f32_16x16x32_bf16 v[32:35], a[60:63], v[120:123], v[32:35]
    v_lshlrev_b32 v16, 16, v126
    v_and_b32 v17, s31, v126
    v_mfma_f32_16x16x32_bf16 v[36:39], a[64:67], v[120:123], v[36:39]
    v_mul_f32 v14, v14, v86
    v_mul_f32 v15, v15, v87
    v_mfma_f32_16x16x32_bf16 v[40:43], a[68:71], v[120:123], v[40:43]
    v_cvt_pk_bf16_f32 v124, v12, v13
    v_lshlrev_b32 v18, 16, v127
    v_mfma_f32_16x16x32_bf16 v[44:47], a[72:75], v[120:123], v[44:47]
    v_and_b32 v19, s31, v127
    v_mul_f32 v16, v16, v88
    v_mfma_f32_16x16x32_bf16 v[48:51], a[76:79], v[120:123], v[48:51]
    v_mul_f32 v17, v17, v89
    v_cvt_pk_bf16_f32 v125, v14, v15
    v_mfma_f32_16x16x32_bf16 v[52:55], a[80:83], v[120:123], v[52:55]
    v_mul_f32 v18, v18, v90
    v_mul_f32 v19, v19, v91
    v_mfma_f32_16x16x32_bf16 v[56:59], a[84:87], v[120:123], v[56:59]
    v_cvt_pk_bf16_f32 v126, v16, v17
    v_cvt_pk_bf16_f32 v127, v18, v19
    v_mfma_f32_16x16x32_bf16 v[60:63], a[88:91], v[120:123], v[60:63]
    v_mfma_f32_16x16x32_bf16 v[64:67], a[92:95], v[120:123], v[64:67]
    s_waitcnt lgkmcnt(2)
    v_mfma_f32_16x16x32_bf16 v[20:23], a[96:99], v[124:127], v[20:23]
    v_lshlrev_b32 v12, 16, v128
    v_and_b32 v13, s31, v128
    v_mfma_f32_16x16x32_bf16 v[24:27], a[100:103], v[124:127], v[24:27]
    v_lshlrev_b32 v14, 16, v129
    v_and_b32 v15, s31, v129
    v_mfma_f32_16x16x32_bf16 v[28:31], a[104:107], v[124:127], v[28:31]
    v_mul_f32 v12, v12, v92
    v_mul_f32 v13, v13, v93
    v_mfma_f32_16x16x32_bf16 v[32:35], a[108:111], v[124:127], v[32:35]
    v_lshlrev_b32 v16, 16, v130
    v_and_b32 v17, s31, v130
    v_mfma_f32_16x16x32_bf16 v[36:39], a[112:115], v[124:127], v[36:39]
    v_mul_f32 v14, v14, v94
    v_mul_f32 v15, v15, v95
    v_mfma_f32_16x16x32_bf16 v[40:43], a[116:119], v[124:127], v[40:43]
    v_cvt_pk_bf16_f32 v128, v12, v13
    v_lshlrev_b32 v18, 16, v131
    v_mfma_f32_16x16x32_bf16 v[44:47], a[120:123], v[124:127], v[44:47]
    v_and_b32 v19, s31, v131
    v_mul_f32 v16, v16, v96
    v_mfma_f32_16x16x32_bf16 v[48:51], a[124:127], v[124:127], v[48:51]
    v_mul_f32 v17, v17, v97
    v_cvt_pk_bf16_f32 v129, v14, v15
    v_mfma_f32_16x16x32_bf16 v[52:55], a[128:131], v[124:127], v[52:55]
    v_mul_f32 v18, v18, v98
    v_mul_f32 v19, v19, v99
    v_mfma_f32_16x16x32_bf16 v[56:59], a[132:135], v[124:127], v[56:59]
    v_cvt_pk_bf16_f32 v130, v16, v17
    v_cvt_pk_bf16_f32 v131, v18, v19
    v_mfma_f32_16x16x32_bf16 v[60:63], a[136:139], v[124:127], v[60:63]
    v_mfma_f32_16x16x32_bf16 v[64:67], a[140:143], v[124:127], v[64:67]
    s_waitcnt lgkmcnt(1)
    v_mfma_f32_16x16x32_bf16 v[20:23], a[144:147], v[128:131], v[20:23]
    v_lshlrev_b32 v12, 16, v132
    v_and_b32 v13, s31, v132
    v_mfma_f32_16x16x32_bf16 v[24:27], a[148:151], v[128:131], v[24:27]
    v_lshlrev_b32 v14, 16, v133
    v_and_b32 v15, s31, v133
    v_mfma_f32_16x16x32_bf16 v[28:31], a[152:155], v[128:131], v[28:31]
    v_mul_f32 v12, v12, v100
    v_mul_f32 v13, v13, v101
    v_mfma_f32_16x16x32_bf16 v[32:35], a[156:159], v[128:131], v[32:35]
    v_lshlrev_b32 v16, 16, v134
    v_and_b32 v17, s31, v134
    v_mfma_f32_16x16x32_bf16 v[36:39], a[160:163], v[128:131], v[36:39]
    v_mul_f32 v14, v14, v102
    v_mul_f32 v15, v15, v103
    v_mfma_f32_16x16x32_bf16 v[40:43], a[164:167], v[128:131], v[40:43]
    v_cvt_pk_bf16_f32 v132, v12, v13
    v_lshlrev_b32 v18, 16, v135
    v_mfma_f32_16x16x32_bf16 v[44:47], a[168:171], v[128:131], v[44:47]
    v_and_b32 v19, s31, v135
    v_mul_f32 v16, v16, v104
    v_mfma_f32_16x16x32_bf16 v[48:51], a[172:175], v[128:131], v[48:51]
    v_mul_f32 v17, v17, v105
    v_cvt_pk_bf16_f32 v133, v14, v15
    v_mfma_f32_16x16x32_bf16 v[52:55], a[176:179], v[128:131], v[52:55]
    v_mul_f32 v18, v18, v106
    v_mul_f32 v19, v19, v107
    v_mfma_f32_16x16x32_bf16 v[56:59], a[180:183], v[128:131], v[56:59]
    v_cvt_pk_bf16_f32 v134, v16, v17
    v_cvt_pk_bf16_f32 v135, v18, v19
    v_mfma_f32_16x16x32_bf16 v[60:63], a[184:187], v[128:131], v[60:63]
    v_mfma_f32_16x16x32_bf16 v[64:67], a[188:191], v[128:131], v[64:67]
    s_waitcnt lgkmcnt(0)
    v_mfma_f32_16x16x32_bf16 v[20:23], a[192:195], v[132:135], v[20:23]
    v_lshlrev_b32 v12, 16, v136
    v_and_b32 v13, s31, v136
    v_mfma_f32_16x16x32_bf16 v[24:27], a[196:199], v[132:135], v[24:27]
    v_lshlrev_b32 v14, 16, v137
    v_and_b32 v15, s31, v137
    v_mfma_f32_16x16x32_bf16 v[28:31], a[200:203], v[132:135], v[28:31]
    v_mul_f32 v12, v12, v108
    v_mul_f32 v13, v13, v109
    v_mfma_f32_16x16x32_bf16 v[32:35], a[204:207], v[132:135], v[32:35]
    v_lshlrev_b32 v16, 16, v138
    v_and_b32 v17, s31, v138
    v_mfma_f32_16x16x32_bf16 v[36:39], a[208:211], v[132:135], v[36:39]
    v_mul_f32 v14, v14, v110
    v_mul_f32 v15, v15, v111
    v_mfma_f32_16x16x32_bf16 v[40:43], a[212:215], v[132:135], v[40:43]
    v_cvt_pk_bf16_f32 v136, v12, v13
    v_lshlrev_b32 v18, 16, v139
    v_mfma_f32_16x16x32_bf16 v[44:47], a[216:219], v[132:135], v[44:47]
    v_and_b32 v19, s31, v139
    v_mul_f32 v16, v16, v112
    v_mfma_f32_16x16x32_bf16 v[48:51], a[220:223], v[132:135], v[48:51]
    v_mul_f32 v17, v17, v113
    v_cvt_pk_bf16_f32 v137, v14, v15
    v_mfma_f32_16x16x32_bf16 v[52:55], a[224:227], v[132:135], v[52:55]
    v_mul_f32 v18, v18, v114
    v_mul_f32 v19, v19, v115
    v_mfma_f32_16x16x32_bf16 v[56:59], a[228:231], v[132:135], v[56:59]
    v_cvt_pk_bf16_f32 v138, v16, v17
    v_cvt_pk_bf16_f32 v139, v18, v19
    v_mfma_f32_16x16x32_bf16 v[60:63], a[232:235], v[132:135], v[60:63]
    v_mfma_f32_16x16x32_bf16 v[64:67], a[236:239], v[132:135], v[64:67]
    v_mfma_f32_16x16x32_bf16 v[20:23], a[240:243], v[136:139], v[20:23]
    v_mfma_f32_16x16x32_bf16 v[24:27], a[244:247], v[136:139], v[24:27]
    v_mfma_f32_16x16x32_bf16 v[28:31], a[248:251], v[136:139], v[28:31]
    v_mfma_f32_16x16x32_bf16 v[32:35], a[252:255], v[136:139], v[32:35]
    v_mfma_f32_16x16x32_bf16 v[36:39], v[164:167], v[136:139], v[36:39]
    v_mfma_f32_16x16x32_bf16 v[40:43], v[168:171], v[136:139], v[40:43]
    v_mfma_f32_16x16x32_bf16 v[44:47], v[172:175], v[136:139], v[44:47]
    v_mfma_f32_16x16x32_bf16 v[48:51], v[176:179], v[136:139], v[48:51]
    v_mfma_f32_16x16x32_bf16 v[52:55], v[180:183], v[136:139], v[52:55]
    v_mfma_f32_16x16x32_bf16 v[56:59], v[184:187], v[136:139], v[56:59]
    v_mfma_f32_16x16x32_bf16 v[60:63], v[188:191], v[136:139], v[60:63]
    v_mfma_f32_16x16x32_bf16 v[64:67], v[192:195], v[136:139], v[64:67]
    v_cvt_pk_bf16_f32 v140, v20, v21
    v_cvt_pk_bf16_f32 v141, v22, v23
    v_cvt_pk_bf16_f32 v142, v24, v25
    v_cvt_pk_bf16_f32 v143, v26, v27
    ds_write_b64 v7, v[140:141] offset:6400
    ds_write_b64 v8, v[142:143] offset:6400
    v_cvt_pk_bf16_f32 v144, v28, v29
    v_cvt_pk_bf16_f32 v145, v30, v31
    v_cvt_pk_bf16_f32 v146, v32, v33
    v_cvt_pk_bf16_f32 v147, v34, v35
    ds_write_b64 v7, v[144:145] offset:6464
    ds_write_b64 v8, v[146:147] offset:6464
    v_cvt_pk_bf16_f32 v148, v36, v37
    v_cvt_pk_bf16_f32 v149, v38, v39
    v_cvt_pk_bf16_f32 v150, v40, v41
    v_cvt_pk_bf16_f32 v151, v42, v43
    ds_write_b64 v7, v[148:149] offset:6528
    ds_write_b64 v8, v[150:151] offset:6528
    v_cvt_pk_bf16_f32 v152, v44, v45
    v_cvt_pk_bf16_f32 v153, v46, v47
    v_cvt_pk_bf16_f32 v154, v48, v49
    v_cvt_pk_bf16_f32 v155, v50, v51
    ds_write_b64 v7, v[152:153] offset:6592
    ds_write_b64 v8, v[154:155] offset:6592
    v_cvt_pk_bf16_f32 v156, v52, v53
    v_cvt_pk_bf16_f32 v157, v54, v55
    v_cvt_pk_bf16_f32 v158, v56, v57
    v_cvt_pk_bf16_f32 v159, v58, v59
    ds_write_b64 v7, v[156:157] offset:6656
    ds_write_b64 v8, v[158:159] offset:6656
    v_cvt_pk_bf16_f32 v160, v60, v61
    v_cvt_pk_bf16_f32 v161, v62, v63
    v_cvt_pk_bf16_f32 v162, v64, v65
    v_cvt_pk_bf16_f32 v163, v66, v67
    ds_write_b64 v7, v[160:161] offset:6720
    ds_write_b64 v8, v[162:163] offset:6720
    ds_read_b128 v[140:143], v196 offset:6400
    ds_read_b128 v[144:147], v197 offset:6400
    ds_read_b128 v[148:151], v198 offset:6400
    ds_read_b128 v[152:155], v196 offset:9600
    ds_read_b128 v[156:159], v197 offset:9600
    ds_read_b128 v[160:163], v198 offset:9600
    s_cmp_lg_u32 s50, 1
    s_cbranch_scc1 L_no_sa
    s_cmp_lg_u32 s62, 1
    s_cbranch_scc1 L_no_sa
    s_mov_b64 exec, 1
    v_mov_b32 v205, s61
    buffer_atomic_or v205, v10, s[40:43], 0 offen
    s_mov_b64 exec, -1
L_no_sa:
    s_add_u32 s59, s50, 2
    s_mov_b32 s35, s30
    s_waitcnt lgkmcnt(5)
    buffer_store_dwordx4 v[140:143], v1, s[16:19], s49 offen offset:0 sc1
    s_lshr_b32 s34, s59, 1
    s_lshl_b32 s34, s34, 11
    s_waitcnt lgkmcnt(4)
    buffer_store_dwordx4 v[144:147], v1, s[16:19], s49 offen offset:1024 sc1
    s_and_b32 s58, s59, 1
    s_lshl_b32 s58, s58, 7
    s_waitcnt lgkmcnt(3)
    buffer_store_dwordx4 v[148:151], v1, s[16:19], s49 offen offset:2048 sc1
    s_add_u32 s34, s34, s58
    s_add_u32 s34, s34, s35
    s_waitcnt lgkmcnt(2)
    buffer_store_dwordx4 v[152:155], v1, s[16:19], s49 offen offset:3072 sc1
    s_add_u32 s34, s34, s29
    s_mul_i32 s34, s34, 6144
    s_waitcnt lgkmcnt(1)
    buffer_store_dwordx4 v[156:159], v2, s[16:19], s49 offen offset:0 sc1
    s_cmp_lt_u32 s59, 16
    s_cselect_b32 s58, s34, 117440512
    s_waitcnt lgkmcnt(0)
    buffer_store_dwordx4 v[160:163], v2, s[16:19], s49 offen offset:1024 sc1
    s_mov_b32 s49, s58
    s_add_u32 s50, s50, 1
    s_add_u32 m0, s33, 6400
    s_nop 0
    buffer_load_dwordx4 v1, s[12:15], s49 offen offset:0 nt lds
    buffer_load_dwordx4 v1, s[12:15], s49 offen offset:1024 nt lds
    buffer_load_dwordx4 v1, s[12:15], s49 offen offset:2048 nt lds
    buffer_load_dwordx4 v1, s[12:15], s49 offen offset:3072 nt lds
    s_add_u32 m0, s33, 10496
    s_nop 0
    buffer_load_dwordx4 v2, s[12:15], s49 offen offset:0 nt lds
    buffer_load_dwordx4 v2, s[12:15], s49 offen offset:1024 nt lds
    s_waitcnt vmcnt(12)
    ds_read_b128 v[116:119], v6 offset:0
    ds_read_b128 v[120:123], v6 offset:64
    ds_read_b128 v[124:127], v6 offset:128
    ds_read_b128 v[128:131], v6 offset:192
    ds_read_b128 v[132:135], v6 offset:256
    ds_read_b128 v[136:139], v6 offset:320
    s_waitcnt lgkmcnt(5)
    v_lshlrev_b32 v12, 16, v116
    v_and_b32 v13, s31, v116
    v_lshlrev_b32 v14, 16, v117
    v_and_b32 v15, s31, v117
    v_mul_f32 v12, v12, v68
    v_mul_f32 v13, v13, v69
    v_lshlrev_b32 v16, 16, v118
    v_and_b32 v17, s31, v118
    v_mul_f32 v14, v14, v70
    v_mul_f32 v15, v15, v71
    v_cvt_pk_bf16_f32 v116, v12, v13
    v_lshlrev_b32 v18, 16, v119
    v_and_b32 v19, s31, v119
    v_mul_f32 v16, v16, v72
    v_mul_f32 v17, v17, v73
    v_cvt_pk_bf16_f32 v117, v14, v15
    v_mul_f32 v18, v18, v74
    v_mul_f32 v19, v19, v75
    v_cvt_pk_bf16_f32 v118, v16, v17
    v_cvt_pk_bf16_f32 v119, v18, v19
    s_nop 1
    s_waitcnt lgkmcnt(4)
    v_mfma_f32_16x16x32_bf16 v[20:23], a[0:3], v[116:119], 0
    v_lshlrev_b32 v12, 16, v120
    v_and_b32 v13, s31, v120
    v_mfma_f32_16x16x32_bf16 v[24:27], a[4:7], v[116:119], 0
    v_lshlrev_b32 v14, 16, v121
    v_and_b32 v15, s31, v121
    v_mfma_f32_16x16x32_bf16 v[28:31], a[8:11], v[116:119], 0
    v_mul_f32 v12, v12, v76
    v_mul_f32 v13, v13, v77
    v_mfma_f32_16x16x32_bf16 v[32:35], a[12:15], v[116:119], 0
    v_lshlrev_b32 v16, 16, v122
    v_and_b32 v17, s31, v122
    v_mfma_f32_16x16x32_bf16 v[36:39], a[16:19], v[116:119], 0
    v_mul_f32 v14, v14, v78
    v_mul_f32 v15, v15, v79
    v_mfma_f32_16x16x32_bf16 v[40:43], a[20:23], v[116:119], 0
    v_cvt_pk_bf16_f32 v120, v12, v13
    v_lshlrev_b32 v18, 16, v123
    v_mfma_f32_16x16x32_bf16 v[44:47], a[24:27], v[116:119], 0
    v_and_b32 v19, s31, v123
    v_mul_f32 v16, v16, v80
    v_mfma_f32_16x16x32_bf16 v[48:51], a[28:31], v[116:119], 0
    v_mul_f32 v17, v17, v81
    v_cvt_pk_bf16_f32 v121, v14, v15
    v_mfma_f32_16x16x32_bf16 v[52:55], a[32:35], v[116:119], 0
    v_mul_f32 v18, v18, v82
    v_mul_f32 v19, v19, v83
    v_mfma_f32_16x16x32_bf16 v[56:59], a[36:39], v[116:119], 0
    v_cvt_pk_bf16_f32 v122, v16, v17
    v_cvt_pk_bf16_f32 v123, v18, v19
    v_mfma_f32_16x16x32_bf16 v[60:63], a[40:43], v[116:119], 0
    v_mfma_f32_16x16x32_bf16 v[64:67], a[44:47], v[116:119], 0
    s_waitcnt lgkmcnt(3)
    v_mfma_f32_16x16x32_bf16 v[20:23], a[48:51], v[120:123], v[20:23]
    v_lshlrev_b32 v12, 16, v124
    v_and_b32 v13, s31, v124
    v_mfma_f32_16x16x32_bf16 v[24:27], a[52:55], v[120:123], v[24:27]
    v_lshlrev_b32 v14, 16, v125
    v_and_b32 v15, s31, v125
    v_mfma_f32_16x16x32_bf16 v[28:31], a[56:59], v[120:123], v[28:31]
    v_mul_f32 v12, v12, v84
    v_mul_f32 v13, v13, v85
    v_mfma_f32_16x16x32_bf16 v[32:35], a[60:63], v[120:123], v[32:35]
    v_lshlrev_b32 v16, 16, v126
    v_and_b32 v17, s31, v126
    v_mfma_f32_16x16x32_bf16 v[36:39], a[64:67], v[120:123], v[36:39]
    v_mul_f32 v14, v14, v86
    v_mul_f32 v15, v15, v87
    v_mfma_f32_16x16x32_bf16 v[40:43], a[68:71], v[120:123], v[40:43]
    v_cvt_pk_bf16_f32 v124, v12, v13
    v_lshlrev_b32 v18, 16, v127
    v_mfma_f32_16x16x32_bf16 v[44:47], a[72:75], v[120:123], v[44:47]
    v_and_b32 v19, s31, v127
    v_mul_f32 v16, v16, v88
    v_mfma_f32_16x16x32_bf16 v[48:51], a[76:79], v[120:123], v[48:51]
    v_mul_f32 v17, v17, v89
    v_cvt_pk_bf16_f32 v125, v14, v15
    v_mfma_f32_16x16x32_bf16 v[52:55], a[80:83], v[120:123], v[52:55]
    v_mul_f32 v18, v18, v90
    v_mul_f32 v19, v19, v91
    v_mfma_f32_16x16x32_bf16 v[56:59], a[84:87], v[120:123], v[56:59]
    v_cvt_pk_bf16_f32 v126, v16, v17
    v_cvt_pk_bf16_f32 v127, v18, v19
    v_mfma_f32_16x16x32_bf16 v[60:63], a[88:91], v[120:123], v[60:63]
    v_mfma_f32_16x16x32_bf16 v[64:67], a[92:95], v[120:123], v[64:67]
    s_waitcnt lgkmcnt(2)
    v_mfma_f32_16x16x32_bf16 v[20:23], a[96:99], v[124:127], v[20:23]
    v_lshlrev_b32 v12, 16, v128
    v_and_b32 v13, s31, v128
    v_mfma_f32_16x16x32_bf16 v[24:27], a[100:103], v[124:127], v[24:27]
    v_lshlrev_b32 v14, 16, v129
    v_and_b32 v15, s31, v129
    v_mfma_f32_16x16x32_bf16 v[28:31], a[104:107], v[124:127], v[28:31]
    v_mul_f32 v12, v12, v92
    v_mul_f32 v13, v13, v93
    v_mfma_f32_16x16x32_bf16 v[32:35], a[108:111], v[124:127], v[32:35]
    v_lshlrev_b32 v16, 16, v130
    v_and_b32 v17, s31, v130
    v_mfma_f32_16x16x32_bf16 v[36:39], a[112:115], v[124:127], v[36:39]
    v_mul_f32 v14, v14, v94
    v_mul_f32 v15, v15, v95
    v_mfma_f32_16x16x32_bf16 v[40:43], a[116:119], v[124:127], v[40:43]
    v_cvt_pk_bf16_f32 v128, v12, v13
    v_lshlrev_b32 v18, 16, v131
    v_mfma_f32_16x16x32_bf16 v[44:47], a[120:123], v[124:127], v[44:47]
    v_and_b32 v19, s31, v131
    v_mul_f32 v16, v16, v96
    v_mfma_f32_16x16x32_bf16 v[48:51], a[124:127], v[124:127], v[48:51]
    v_mul_f32 v17, v17, v97
    v_cvt_pk_bf16_f32 v129, v14, v15
    v_mfma_f32_16x16x32_bf16 v[52:55], a[128:131], v[124:127], v[52:55]
    v_mul_f32 v18, v18, v98
    v_mul_f32 v19, v19, v99
    v_mfma_f32_16x16x32_bf16 v[56:59], a[132:135], v[124:127], v[56:59]
    v_cvt_pk_bf16_f32 v130, v16, v17
    v_cvt_pk_bf16_f32 v131, v18, v19
    v_mfma_f32_16x16x32_bf16 v[60:63], a[136:139], v[124:127], v[60:63]
    v_mfma_f32_16x16x32_bf16 v[64:67], a[140:143], v[124:127], v[64:67]
    s_waitcnt lgkmcnt(1)
    v_mfma_f32_16x16x32_bf16 v[20:23], a[144:147], v[128:131], v[20:23]
    v_lshlrev_b32 v12, 16, v132
    v_and_b32 v13, s31, v132
    v_mfma_f32_16x16x32_bf16 v[24:27], a[148:151], v[128:131], v[24:27]
    v_lshlrev_b32 v14, 16, v133
    v_and_b32 v15, s31, v133
    v_mfma_f32_16x16x32_bf16 v[28:31], a[152:155], v[128:131], v[28:31]
    v_mul_f32 v12, v12, v100
    v_mul_f32 v13, v13, v101
    v_mfma_f32_16x16x32_bf16 v[32:35], a[156:159], v[128:131], v[32:35]
    v_lshlrev_b32 v16, 16, v134
    v_and_b32 v17, s31, v134
    v_mfma_f32_16x16x32_bf16 v[36:39], a[160:163], v[128:131], v[36:39]
    v_mul_f32 v14, v14, v102
    v_mul_f32 v15, v15, v103
    v_mfma_f32_16x16x32_bf16 v[40:43], a[164:167], v[128:131], v[40:43]
    v_cvt_pk_bf16_f32 v132, v12, v13
    v_lshlrev_b32 v18, 16, v135
    v_mfma_f32_16x16x32_bf16 v[44:47], a[168:171], v[128:131], v[44:47]
    v_and_b32 v19, s31, v135
    v_mul_f32 v16, v16, v104
    v_mfma_f32_16x16x32_bf16 v[48:51], a[172:175], v[128:131], v[48:51]
    v_mul_f32 v17, v17, v105
    v_cvt_pk_bf16_f32 v133, v14, v15
    v_mfma_f32_16x16x32_bf16 v[52:55], a[176:179], v[128:131], v[52:55]
    v_mul_f32 v18, v18, v106
    v_mul_f32 v19, v19, v107
    v_mfma_f32_16x16x32_bf16 v[56:59], a[180:183], v[128:131], v[56:59]
    v_cvt_pk_bf16_f32 v134, v16, v17
    v_cvt_pk_bf16_f32 v135, v18, v19
    v_mfma_f32_16x16x32_bf16 v[60:63], a[184:187], v[128:131], v[60:63]
    v_mfma_f32_16x16x32_bf16 v[64:67], a[188:191], v[128:131], v[64:67]
    s_waitcnt lgkmcnt(0)
    v_mfma_f32_16x16x32_bf16 v[20:23], a[192:195], v[132:135], v[20:23]
    v_lshlrev_b32 v12, 16, v136
    v_and_b32 v13, s31, v136
    v_mfma_f32_16x16x32_bf16 v[24:27], a[196:199], v[132:135], v[24:27]
    v_lshlrev_b32 v14, 16, v137
    v_and_b32 v15, s31, v137
    v_mfma_f32_16x16x32_bf16 v[28:31], a[200:203], v[132:135], v[28:31]
    v_mul_f32 v12, v12, v108
    v_mul_f32 v13, v13, v109
    v_mfma_f32_16x16x32_bf16 v[32:35], a[204:207], v[132:135], v[32:35]
    v_lshlrev_b32 v16, 16, v138
    v_and_b32 v17, s31, v138
    v_mfma_f32_16x16x32_bf16 v[36:39], a[208:211], v[132:135], v[36:39]
    v_mul_f32 v14, v14, v110
    v_mul_f32 v15, v15, v111
    v_mfma_f32_16x16x32_bf16 v[40:43], a[212:215], v[132:135], v[40:43]
    v_cvt_pk_bf16_f32 v136, v12, v13
    v_lshlrev_b32 v18, 16, v139
    v_mfma_f32_16x16x32_bf16 v[44:47], a[216:219], v[132:135], v[44:47]
    v_and_b32 v19, s31, v139
    v_mul_f32 v16, v16, v112
    v_mfma_f32_16x16x32_bf16 v[48:51], a[220:223], v[132:135], v[48:51]
    v_mul_f32 v17, v17, v113
    v_cvt_pk_bf16_f32 v137, v14, v15
    v_mfma_f32_16x16x32_bf16 v[52:55], a[224:227], v[132:135], v[52:55]
    v_mul_f32 v18, v18, v114
    v_mul_f32 v19, v19, v115
    v_mfma_f32_16x16x32_bf16 v[56:59], a[228:231], v[132:135], v[56:59]
    v_cvt_pk_bf16_f32 v138, v16, v17
    v_cvt_pk_bf16_f32 v139, v18, v19
    v_mfma_f32_16x16x32_bf16 v[60:63], a[232:235], v[132:135], v[60:63]
    v_mfma_f32_16x16x32_bf16 v[64:67], a[236:239], v[132:135], v[64:67]
    v_mfma_f32_16x16x32_bf16 v[20:23], a[240:243], v[136:139], v[20:23]
    v_mfma_f32_16x16x32_bf16 v[24:27], a[244:247], v[136:139], v[24:27]
    v_mfma_f32_16x16x32_bf16 v[28:31], a[248:251], v[136:139], v[28:31]
    v_mfma_f32_16x16x32_bf16 v[32:35], a[252:255], v[136:139], v[32:35]
    v_mfma_f32_16x16x32_bf16 v[36:39], v[164:167], v[136:139], v[36:39]
    v_mfma_f32_16x16x32_bf16 v[40:43], v[168:171], v[136:139], v[40:43]
    v_mfma_f32_16x16x32_bf16 v[44:47], v[172:175], v[136:139], v[44:47]
    v_mfma_f32_16x16x32_bf16 v[48:51], v[176:179], v[136:139], v[48:51]
    v_mfma_f32_16x16x32_bf16 v[52:55], v[180:183], v[136:139], v[52:55]
    v_mfma_f32_16x16x32_bf16 v[56:59], v[184:187], v[136:139], v[56:59]
    v_mfma_f32_16x16x32_bf16 v[60:63], v[188:191], v[136:139], v[60:63]
    v_mfma_f32_16x16x32_bf16 v[64:67], v[192:195], v[136:139], v[64:67]
    v_cvt_pk_bf16_f32 v140, v20, v21
    v_cvt_pk_bf16_f32 v141, v22, v23
    v_cvt_pk_bf16_f32 v142, v24, v25
    v_cvt_pk_bf16_f32 v143, v26, v27
    ds_write_b64 v7, v[140:141] offset:0
    ds_write_b64 v8, v[142:143] offset:0
    v_cvt_pk_bf16_f32 v144, v28, v29
    v_cvt_pk_bf16_f32 v145, v30, v31
    v_cvt_pk_bf16_f32 v146, v32, v33
    v_cvt_pk_bf16_f32 v147, v34, v35
    ds_write_b64 v7, v[144:145] offset:64
    ds_write_b64 v8, v[146:147] offset:64
    v_cvt_pk_bf16_f32 v148, v36, v37
    v_cvt_pk_bf16_f32 v149, v38, v39
    v_cvt_pk_bf16_f32 v150, v40, v41
    v_cvt_pk_bf16_f32 v151, v42, v43
    ds_write_b64 v7, v[148:149] offset:128
    ds_write_b64 v8, v[150:151] offset:128
    v_cvt_pk_bf16_f32 v152, v44, v45
    v_cvt_pk_bf16_f32 v153, v46, v47
    v_cvt_pk_bf16_f32 v154, v48, v49
    v_cvt_pk_bf16_f32 v155, v50, v51
    ds_write_b64 v7, v[152:153] offset:192
    ds_write_b64 v8, v[154:155] offset:192
    v_cvt_pk_bf16_f32 v156, v52, v53
    v_cvt_pk_bf16_f32 v157, v54, v55
    v_cvt_pk_bf16_f32 v158, v56, v57
    v_cvt_pk_bf16_f32 v159, v58, v59
    ds_write_b64 v7, v[156:157] offset:256
    ds_write_b64 v8, v[158:159] offset:256
    v_cvt_pk_bf16_f32 v160, v60, v61
    v_cvt_pk_bf16_f32 v161, v62, v63
    v_cvt_pk_bf16_f32 v162, v64, v65
    v_cvt_pk_bf16_f32 v163, v66, v67
    ds_write_b64 v7, v[160:161] offset:320
    ds_write_b64 v8, v[162:163] offset:320
    ds_read_b128 v[140:143], v196 offset:0
    ds_read_b128 v[144:147], v197 offset:0
    ds_read_b128 v[148:151], v198 offset:0
    ds_read_b128 v[152:155], v196 offset:3200
    ds_read_b128 v[156:159], v197 offset:3200
    ds_read_b128 v[160:163], v198 offset:3200
    s_cmp_lg_u32 s50, 1
    s_cbranch_scc1 L_no_sb
    s_cmp_lg_u32 s62, 1
    s_cbranch_scc1 L_no_sb
    s_mov_b64 exec, 1
    v_mov_b32 v205, s61
    buffer_atomic_or v205, v10, s[40:43], 0 offen
    s_mov_b64 exec, -1
L_no_sb:
    s_add_u32 s59, s50, 2
    s_mov_b32 s35, s30
    s_waitcnt lgkmcnt(5)
    buffer_store_dwordx4 v[140:143], v1, s[16:19], s48 offen offset:0 sc1
    s_lshr_b32 s34, s59, 1
    s_lshl_b32 s34, s34, 11
    s_waitcnt lgkmcnt(4)
    buffer_store_dwordx4 v[144:147], v1, s[16:19], s48 offen offset:1024 sc1
    s_and_b32 s58, s59, 1
    s_lshl_b32 s58, s58, 7
    s_waitcnt lgkmcnt(3)
    buffer_store_dwordx4 v[148:151], v1, s[16:19], s48 offen offset:2048 sc1
    s_add_u32 s34, s34, s58
    s_add_u32 s34, s34, s35
    s_waitcnt lgkmcnt(2)
    buffer_store_dwordx4 v[152:155], v1, s[16:19], s48 offen offset:3072 sc1
    s_add_u32 s34, s34, s29
    s_mul_i32 s34, s34, 6144
    s_waitcnt lgkmcnt(1)
    buffer_store_dwordx4 v[156:159], v2, s[16:19], s48 offen offset:0 sc1
    s_cmp_lt_u32 s59, 16
    s_cselect_b32 s58, s34, 117440512
    s_waitcnt lgkmcnt(0)
    buffer_store_dwordx4 v[160:163], v2, s[16:19], s48 offen offset:1024 sc1
    s_mov_b32 s48, s58
    s_add_u32 s50, s50, 1
    s_add_u32 m0, s33, 0
    s_nop 0
    buffer_load_dwordx4 v1, s[12:15], s48 offen offset:0 nt lds
    buffer_load_dwordx4 v1, s[12:15], s48 offen offset:1024 nt lds
    buffer_load_dwordx4 v1, s[12:15], s48 offen offset:2048 nt lds
    buffer_load_dwordx4 v1, s[12:15], s48 offen offset:3072 nt lds
    s_add_u32 m0, s33, 4096
    s_nop 0
    buffer_load_dwordx4 v2, s[12:15], s48 offen offset:0 nt lds
    buffer_load_dwordx4 v2, s[12:15], s48 offen offset:1024 nt lds
    s_cmp_lt_u32 s50, 9
    s_cbranch_scc1 L_sloop
    s_waitcnt vmcnt(12)
L_loop:
    s_cmp_ge_u32 s49, 100663296
    s_cbranch_scc1 L_end
    s_waitcnt vmcnt(13)
    ds_read_b128 v[116:119], v6 offset:6400
    ds_read_b128 v[120:123], v6 offset:6464
    ds_read_b128 v[124:127], v6 offset:6528
    ds_read_b128 v[128:131], v6 offset:6592
    ds_read_b128 v[132:135], v6 offset:6656
    ds_read_b128 v[136:139], v6 offset:6720
    s_waitcnt lgkmcnt(5)
    v_lshlrev_b32 v12, 16, v116
    v_and_b32 v13, s31, v116
    v_lshlrev_b32 v14, 16, v117
    v_and_b32 v15, s31, v117
    v_mul_f32 v12, v12, v68
    v_mul_f32 v13, v13, v69
    v_lshlrev_b32 v16, 16, v118
    v_and_b32 v17, s31, v118
    v_mul_f32 v14, v14, v70
    v_mul_f32 v15, v15, v71
    v_cvt_pk_bf16_f32 v116, v12, v13
    v_lshlrev_b32 v18, 16, v119
    v_and_b32 v19, s31, v119
    v_mul_f32 v16, v16, v72
    v_mul_f32 v17, v17, v73
    v_cvt_pk_bf16_f32 v117, v14, v15
    v_mul_f32 v18, v18, v74
    v_mul_f32 v19, v19, v75
    v_cvt_pk_bf16_f32 v118, v16, v17
    v_cvt_pk_bf16_f32 v119, v18, v19
    s_nop 1
    s_waitcnt lgkmcnt(4)
    v_mfma_f32_16x16x32_bf16 v[20:23], a[0:3], v[116:119], 0
    v_lshlrev_b32 v12, 16, v120
    v_and_b32 v13, s31, v120
    v_mfma_f32_16x16x32_bf16 v[24:27], a[4:7], v[116:119], 0
    v_lshlrev_b32 v14, 16, v121
    v_and_b32 v15, s31, v121
    v_mfma_f32_16x16x32_bf16 v[28:31], a[8:11], v[116:119], 0
    v_mul_f32 v12, v12, v76
    v_mul_f32 v13, v13, v77
    v_mfma_f32_16x16x32_bf16 v[32:35], a[12:15], v[116:119], 0
    v_lshlrev_b32 v16, 16, v122
    v_and_b32 v17, s31, v122
    v_mfma_f32_16x16x32_bf16 v[36:39], a[16:19], v[116:119], 0
    v_mul_f32 v14, v14, v78
    v_mul_f32 v15, v15, v79
    v_mfma_f32_16x16x32_bf16 v[40:43], a[20:23], v[116:119], 0
    v_cvt_pk_bf16_f32 v120, v12, v13
    v_lshlrev_b32 v18, 16, v123
    v_mfma_f32_16x16x32_bf16 v[44:47], a[24:27], v[116:119], 0
    v_and_b32 v19, s31, v123
    v_mul_f32 v16, v16, v80
    v_mfma_f32_16x16x32_bf16 v[48:51], a[28:31], v[116:119], 0
    v_mul_f32 v17, v17, v81
    v_cvt_pk_bf16_f32 v121, v14, v15
    v_mfma_f32_16x16x32_bf16 v[52:55], a[32:35], v[116:119], 0
    v_mul_f32 v18, v18, v82
    v_mul_f32 v19, v19, v83
    v_mfma_f32_16x16x32_bf16 v[56:59], a[36:39], v[116:119], 0
    v_cvt_pk_bf16_f32 v122, v16, v17
    v_cvt_pk_bf16_f32 v123, v18, v19
    v_mfma_f32_16x16x32_bf16 v[60:63], a[40:43], v[116:119], 0
    v_mfma_f32_16x16x32_bf16 v[64:67], a[44:47], v[116:119], 0
    s_waitcnt lgkmcnt(3)
    v_mfma_f32_16x16x32_bf16 v[20:23], a[48:51], v[120:123], v[20:23]
    v_lshlrev_b32 v12, 16, v124
    v_and_b32 v13, s31, v124
    v_mfma_f32_16x16x32_bf16 v[24:27], a[52:55], v[120:123], v[24:27]
    v_lshlrev_b32 v14, 16, v125
    v_and_b32 v15, s31, v125
    v_mfma_f32_16x16x32_bf16 v[28:31], a[56:59], v[120:123], v[28:31]
    v_mul_f32 v12, v12, v84
    v_mul_f32 v13, v13, v85
    v_mfma_f32_16x16x32_bf16 v[32:35], a[60:63], v[120:123], v[32:35]
    v_lshlrev_b32 v16, 16, v126
    v_and_b32 v17, s31, v126
    v_mfma_f32_16x16x32_bf16 v[36:39], a[64:67], v[120:123], v[36:39]
    v_mul_f32 v14, v14, v86
    v_mul_f32 v15, v15, v87
    v_mfma_f32_16x16x32_bf16 v[40:43], a[68:71], v[120:123], v[40:43]
    v_cvt_pk_bf16_f32 v124, v12, v13
    v_lshlrev_b32 v18, 16, v127
    v_mfma_f32_16x16x32_bf16 v[44:47], a[72:75], v[120:123], v[44:47]
    v_and_b32 v19, s31, v127
    v_mul_f32 v16, v16, v88
    v_mfma_f32_16x16x32_bf16 v[48:51], a[76:79], v[120:123], v[48:51]
    v_mul_f32 v17, v17, v89
    v_cvt_pk_bf16_f32 v125, v14, v15
    v_mfma_f32_16x16x32_bf16 v[52:55], a[80:83], v[120:123], v[52:55]
    v_mul_f32 v18, v18, v90
    v_mul_f32 v19, v19, v91
    v_mfma_f32_16x16x32_bf16 v[56:59], a[84:87], v[120:123], v[56:59]
    v_cvt_pk_bf16_f32 v126, v16, v17
    v_cvt_pk_bf16_f32 v127, v18, v19
    v_mfma_f32_16x16x32_bf16 v[60:63], a[88:91], v[120:123], v[60:63]
    v_mfma_f32_16x16x32_bf16 v[64:67], a[92:95], v[120:123], v[64:67]
    s_waitcnt lgkmcnt(2)
    v_mfma_f32_16x16x32_bf16 v[20:23], a[96:99], v[124:127], v[20:23]
    v_lshlrev_b32 v12, 16, v128
    v_and_b32 v13, s31, v128
    v_mfma_f32_16x16x32_bf16 v[24:27], a[100:103], v[124:127], v[24:27]
    v_lshlrev_b32 v14, 16, v129
    v_and_b32 v15, s31, v129
    v_mfma_f32_16x16x32_bf16 v[28:31], a[104:107], v[124:127], v[28:31]
    v_mul_f32 v12, v12, v92
    v_mul_f32 v13, v13, v93
    v_mfma_f32_16x16x32_bf16 v[32:35], a[108:111], v[124:127], v[32:35]
    v_lshlrev_b32 v16, 16, v130
    v_and_b32 v17, s31, v130
    v_mfma_f32_16x16x32_bf16 v[36:39], a[112:115], v[124:127], v[36:39]
    v_mul_f32 v14, v14, v94
    v_mul_f32 v15, v15, v95
    v_mfma_f32_16x16x32_bf16 v[40:43], a[116:119], v[124:127], v[40:43]
    v_cvt_pk_bf16_f32 v128, v12, v13
    v_lshlrev_b32 v18, 16, v131
    v_mfma_f32_16x16x32_bf16 v[44:47], a[120:123], v[124:127], v[44:47]
    v_and_b32 v19, s31, v131
    v_mul_f32 v16, v16, v96
    v_mfma_f32_16x16x32_bf16 v[48:51], a[124:127], v[124:127], v[48:51]
    v_mul_f32 v17, v17, v97
    v_cvt_pk_bf16_f32 v129, v14, v15
    v_mfma_f32_16x16x32_bf16 v[52:55], a[128:131], v[124:127], v[52:55]
    v_mul_f32 v18, v18, v98
    v_mul_f32 v19, v19, v99
    v_mfma_f32_16x16x32_bf16 v[56:59], a[132:135], v[124:127], v[56:59]
    v_cvt_pk_bf16_f32 v130, v16, v17
    v_cvt_pk_bf16_f32 v131, v18, v19
    v_mfma_f32_16x16x32_bf16 v[60:63], a[136:139], v[124:127], v[60:63]
    v_mfma_f32_16x16x32_bf16 v[64:67], a[140:143], v[124:127], v[64:67]
    s_waitcnt lgkmcnt(1)
    v_mfma_f32_16x16x32_bf16 v[20:23], a[144:147], v[128:131], v[20:23]
    v_lshlrev_b32 v12, 16, v132
    v_and_b32 v13, s31, v132
    v_mfma_f32_16x16x32_bf16 v[24:27], a[148:151], v[128:131], v[24:27]
    v_lshlrev_b32 v14, 16, v133
    v_and_b32 v15, s31, v133
    v_mfma_f32_16x16x32_bf16 v[28:31], a[152:155], v[128:131], v[28:31]
    v_mul_f32 v12, v12, v100
    v_mul_f32 v13, v13, v101
    v_mfma_f32_16x16x32_bf16 v[32:35], a[156:159], v[128:131], v[32:35]
    v_lshlrev_b32 v16, 16, v134
    v_and_b32 v17, s31, v134
    v_mfma_f32_16x16x32_bf16 v[36:39], a[160:163], v[128:131], v[36:39]
    v_mul_f32 v14, v14, v102
    v_mul_f32 v15, v15, v103
    v_mfma_f32_16x16x32_bf16 v[40:43], a[164:167], v[128:131], v[40:43]
    v_cvt_pk_bf16_f32 v132, v12, v13
    v_lshlrev_b32 v18, 16, v135
    v_mfma_f32_16x16x32_bf16 v[44:47], a[168:171], v[128:131], v[44:47]
    v_and_b32 v19, s31, v135
    v_mul_f32 v16, v16, v104
    v_mfma_f32_16x16x32_bf16 v[48:51], a[172:175], v[128:131], v[48:51]
    v_mul_f32 v17, v17, v105
    v_cvt_pk_bf16_f32 v133, v14, v15
    v_mfma_f32_16x16x32_bf16 v[52:55], a[176:179], v[128:131], v[52:55]
    v_mul_f32 v18, v18, v106
    v_mul_f32 v19, v19, v107
    v_mfma_f32_16x16x32_bf16 v[56:59], a[180:183], v[128:131], v[56:59]
    v_cvt_pk_bf16_f32 v134, v16, v17
    v_cvt_pk_bf16_f32 v135, v18, v19
    v_mfma_f32_16x16x32_bf16 v[60:63], a[184:187], v[128:131], v[60:63]
    v_mfma_f32_16x16x32_bf16 v[64:67], a[188:191], v[128:131], v[64:67]
    s_waitcnt lgkmcnt(0)
    v_mfma_f32_16x16x32_bf16 v[20:23], a[192:195], v[132:135], v[20:23]
    v_lshlrev_b32 v12, 16, v136
    v_and_b32 v13, s31, v136
    v_mfma_f32_16x16x32_bf16 v[24:27], a[196:199], v[132:135], v[24:27]
    v_lshlrev_b32 v14, 16, v137
    v_and_b32 v15, s31, v137
    v_mfma_f32_16x16x32_bf16 v[28:31], a[200:203], v[132:135], v[28:31]
    v_mul_f32 v12, v12, v108
    v_mul_f32 v13, v13, v109
    v_mfma_f32_16x16x32_bf16 v[32:35], a[204:207], v[132:135], v[32:35]
    v_lshlrev_b32 v16, 16, v138
    v_and_b32 v17, s31, v138
    v_mfma_f32_16x16x32_bf16 v[36:39], a[208:211], v[132:135], v[36:39]
    v_mul_f32 v14, v14, v110
    v_mul_f32 v15, v15, v111
    v_mfma_f32_16x16x32_bf16 v[40:43], a[212:215], v[132:135], v[40:43]
    v_cvt_pk_bf16_f32 v136, v12, v13
    v_lshlrev_b32 v18, 16, v139
    v_mfma_f32_16x16x32_bf16 v[44:47], a[216:219], v[132:135], v[44:47]
    v_and_b32 v19, s31, v139
    v_mul_f32 v16, v16, v112
    v_mfma_f32_16x16x32_bf16 v[48:51], a[220:223], v[132:135], v[48:51]
    v_mul_f32 v17, v17, v113
    v_cvt_pk_bf16_f32 v137, v14, v15
    v_mfma_f32_16x16x32_bf16 v[52:55], a[224:227], v[132:135], v[52:55]
    v_mul_f32 v18, v18, v114
    v_mul_f32 v19, v19, v115
    v_mfma_f32_16x16x32_bf16 v[56:59], a[228:231], v[132:135], v[56:59]
    v_cvt_pk_bf16_f32 v138, v16, v17
    v_cvt_pk_bf16_f32 v139, v18, v19
    v_mfma_f32_16x16x32_bf16 v[60:63], a[232:235], v[132:135], v[60:63]
    v_mfma_f32_16x16x32_bf16 v[64:67], a[236:239], v[132:135], v[64:67]
    v_mfma_f32_16x16x32_bf16 v[20:23], a[240:243], v[136:139], v[20:23]
    v_mfma_f32_16x16x32_bf16 v[24:27], a[244:247], v[136:139], v[24:27]
    v_mfma_f32_16x16x32_bf16 v[28:31], a[248:251], v[136:139], v[28:31]
    v_mfma_f32_16x16x32_bf16 v[32:35], a[252:255], v[136:139], v[32:35]
    v_mfma_f32_16x16x32_bf16 v[36:39], v[164:167], v[136:139], v[36:39]
    v_mfma_f32_16x16x32_bf16 v[40:43], v[168:171], v[136:139], v[40:43]
    v_mfma_f32_16x16x32_bf16 v[44:47], v[172:175], v[136:139], v[44:47]
    v_mfma_f32_16x16x32_bf16 v[48:51], v[176:179], v[136:139], v[48:51]
    v_mfma_f32_16x16x32_bf16 v[52:55], v[180:183], v[136:139], v[52:55]
    v_mfma_f32_16x16x32_bf16 v[56:59], v[184:187], v[136:139], v[56:59]
    v_mfma_f32_16x16x32_bf16 v[60:63], v[188:191], v[136:139], v[60:63]
    v_mfma_f32_16x16x32_bf16 v[64:67], v[192:195], v[136:139], v[64:67]
    v_cvt_pk_bf16_f32 v140, v20, v21
    v_cvt_pk_bf16_f32 v141, v22, v23
    v_cvt_pk_bf16_f32 v142, v24, v25
    v_cvt_pk_bf16_f32 v143, v26, v27
    ds_write_b64 v7, v[140:141] offset:6400
    ds_write_b64 v8, v[142:143] offset:6400
    v_cvt_pk_bf16_f32 v144, v28, v29
    v_cvt_pk_bf16_f32 v145, v30, v31
    v_cvt_pk_bf16_f32 v146, v32, v33
    v_cvt_pk_bf16_f32 v147, v34, v35
    ds_write_b64 v7, v[144:145] offset:6464
    ds_write_b64 v8, v[146:147] offset:6464
    v_cvt_pk_bf16_f32 v148, v36, v37
    v_cvt_pk_bf16_f32 v149, v38, v39
    v_cvt_pk_bf16_f32 v150, v40, v41
    v_cvt_pk_bf16_f32 v151, v42, v43
    ds_write_b64 v7, v[148:149] offset:6528
    ds_write_b64 v8, v[150:151] offset:6528
    v_cvt_pk_bf16_f32 v152, v44, v45
    v_cvt_pk_bf16_f32 v153, v46, v47
    v_cvt_pk_bf16_f32 v154, v48, v49
    v_cvt_pk_bf16_f32 v155, v50, v51
    ds_write_b64 v7, v[152:153] offset:6592
    ds_write_b64 v8, v[154:155] offset:6592
    v_cvt_pk_bf16_f32 v156, v52, v53
    v_cvt_pk_bf16_f32 v157, v54, v55
    v_cvt_pk_bf16_f32 v158, v56, v57
    v_cvt_pk_bf16_f32 v159, v58, v59
    ds_write_b64 v7, v[156:157] offset:6656
    ds_write_b64 v8, v[158:159] offset:6656
    v_cvt_pk_bf16_f32 v160, v60, v61
    v_cvt_pk_bf16_f32 v161, v62, v63
    v_cvt_pk_bf16_f32 v162, v64, v65
    v_cvt_pk_bf16_f32 v163, v66, v67
    ds_write_b64 v7, v[160:161] offset:6720
    ds_write_b64 v8, v[162:163] offset:6720
    ds_read_b128 v[140:143], v196 offset:6400
    ds_read_b128 v[144:147], v197 offset:6400
    ds_read_b128 v[148:151], v198 offset:6400
    ds_read_b128 v[152:155], v196 offset:9600
    ds_read_b128 v[156:159], v197 offset:9600
    ds_read_b128 v[160:163], v198 offset:9600
    s_waitcnt vmcnt(12)
    v_readfirstlane_b32 s60, v11
    s_cmp_lg_u32 s50, 10
    s_cbranch_scc1 L_nf_a
    v_readfirstlane_b32 s34, v204
    s_nop 3
    s_and_b32 s34, s34, s61
    s_cselect_b32 s51, 13, 16
    s_cselect_b32 s56, 13, 0xffff
L_nf_a:
    s_mov_b64 exec, 1
    s_cmp_lg_u32 s50, 9
    s_cbranch_scc1 L_nl_a
    buffer_load_dword v204, v10, s[40:43], 0 offen sc0 sc1
L_nl_a:
    s_add_u32 s34, s50, 3
    s_cmp_ge_u32 s34, s56
    s_cselect_b32 s34, s57, 117440512
    v_mov_b32 v11, s71
    buffer_atomic_add v11, v10, s[44:47], s34 offen sc0
    s_mov_b64 exec, -1
    s_add_u32 s59, s50, 2
    s_lshr_b32 s34, s60, s70
    s_and_b32 s34, s34, 0xffff
    s_sub_u32 s35, 95, s34
    s_cmp_lt_u32 s34, 48
    s_waitcnt lgkmcnt(5)
    buffer_store_dwordx4 v[140:143], v1, s[16:19], s49 offen offset:0 sc1
    s_cselect_b32 s34, s34, s35
    s_cselect_b32 s35, s68, s69
    s_and_b32 s58, s34, 15
    s_add_u32 s35, s35, s58
    s_lshr_b32 s34, s34, 4
    s_waitcnt lgkmcnt(4)
    buffer_store_dwordx4 v[144:147], v1, s[16:19], s49 offen offset:1024 sc1
    s_add_u32 s34, s34, s51
    s_and_b32 s58, s60, 0xffff
    s_lshr_b32 s63, s60, 16
    s_add_u32 s58, s58, s63
    s_cmp_lt_u32 s58, 96
    s_waitcnt lgkmcnt(3)
    buffer_store_dwordx4 v[148:151], v1, s[16:19], s49 offen offset:2048 sc1
    s_cselect_b32 s34, s34, 16
    s_add_u32 s58, s30, s29
    s_cmp_lt_u32 s59, s51
    s_cselect_b32 s59, s59, s34
    s_cselect_b32 s35, s58, s35
    s_waitcnt lgkmcnt(2)
    buffer_store_dwordx4 v[152:155], v1, s[16:19], s49 offen offset:3072 sc1
    s_lshr_b32 s34, s59, 1
    s_lshl_b32 s34, s34, 11
    s_and_b32 s58, s59, 1
    s_lshl_b32 s58, s58, 7
    s_add_u32 s34, s34, s58
    s_waitcnt lgkmcnt(1)
    buffer_store_dwordx4 v[156:159], v2, s[16:19], s49 offen offset:0 sc1
    s_add_u32 s34, s34, s35
    s_mul_i32 s34, s34, 6144
    s_cmp_lt_u32 s59, 16
    s_cselect_b32 s58, s34, 117440512
    s_waitcnt lgkmcnt(0)
    buffer_store_dwordx4 v[160:163], v2, s[16:19], s49 offen offset:1024 sc1
    s_mov_b32 s49, s58
    s_add_u32 s50, s50, 1
    s_add_u32 m0, s33, 6400
    s_nop 0
    buffer_load_dwordx4 v1, s[12:15], s49 offen offset:0 nt lds
    buffer_load_dwordx4 v1, s[12:15], s49 offen offset:1024 nt lds
    buffer_load_dwordx4 v1, s[12:15], s49 offen offset:2048 nt lds
    buffer_load_dwordx4 v1, s[12:15], s49 offen offset:3072 nt lds
    s_add_u32 m0, s33, 10496
    s_nop 0
    buffer_load_dwordx4 v2, s[12:15], s49 offen offset:0 nt lds
    buffer_load_dwordx4 v2, s[12:15], s49 offen offset:1024 nt lds
    s_cmp_ge_u32 s48, 100663296
    s_cbranch_scc1 L_end
    s_waitcnt vmcnt(13)
    ds_read_b128 v[116:119], v6 offset:0
    ds_read_b128 v[120:123], v6 offset:64
    ds_read_b128 v[124:127], v6 offset:128
    ds_read_b128 v[128:131], v6 offset:192
    ds_read_b128 v[132:135], v6 offset:256
    ds_read_b128 v[136:139], v6 offset:320
    s_waitcnt lgkmcnt(5)
    v_lshlrev_b32 v12, 16, v116
    v_and_b32 v13, s31, v116
    v_lshlrev_b32 v14, 16, v117
    v_and_b32 v15, s31, v117
    v_mul_f32 v12, v12, v68
    v_mul_f32 v13, v13, v69
    v_lshlrev_b32 v16, 16, v118
    v_and_b32 v17, s31, v118
    v_mul_f32 v14, v14, v70
    v_mul_f32 v15, v15, v71
    v_cvt_pk_bf16_f32 v116, v12, v13
    v_lshlrev_b32 v18, 16, v119
    v_and_b32 v19, s31, v119
    v_mul_f32 v16, v16, v72
    v_mul_f32 v17, v17, v73
    v_cvt_pk_bf16_f32 v117, v14, v15
    v_mul_f32 v18, v18, v74
    v_mul_f32 v19, v19, v75
    v_cvt_pk_bf16_f32 v118, v16, v17
    v_cvt_pk_bf16_f32 v119, v18, v19
    s_nop 1
    s_waitcnt lgkmcnt(4)
    v_mfma_f32_16x16x32_bf16 v[20:23], a[0:3], v[116:119], 0
    v_lshlrev_b32 v12, 16, v120
    v_and_b32 v13, s31, v120
    v_mfma_f32_16x16x32_bf16 v[24:27], a[4:7], v[116:119], 0
    v_lshlrev_b32 v14, 16, v121
    v_and_b32 v15, s31, v121
    v_mfma_f32_16x16x32_bf16 v[28:31], a[8:11], v[116:119], 0
    v_mul_f32 v12, v12, v76
    v_mul_f32 v13, v13, v77
    v_mfma_f32_16x16x32_bf16 v[32:35], a[12:15], v[116:119], 0
    v_lshlrev_b32 v16, 16, v122
    v_and_b32 v17, s31, v122
    v_mfma_f32_16x16x32_bf16 v[36:39], a[16:19], v[116:119], 0
    v_mul_f32 v14, v14, v78
    v_mul_f32 v15, v15, v79
    v_mfma_f32_16x16x32_bf16 v[40:43], a[20:23], v[116:119], 0
    v_cvt_pk_bf16_f32 v120, v12, v13
    v_lshlrev_b32 v18, 16, v123
    v_mfma_f32_16x16x32_bf16 v[44:47], a[24:27], v[116:119], 0
    v_and_b32 v19, s31, v123
    v_mul_f32 v16, v16, v80
    v_mfma_f32_16x16x32_bf16 v[48:51], a[28:31], v[116:119], 0
    v_mul_f32 v17, v17, v81
    v_cvt_pk_bf16_f32 v121, v14, v15
    v_mfma_f32_16x16x32_bf16 v[52:55], a[32:35], v[116:119], 0
    v_mul_f32 v18, v18, v82
    v_mul_f32 v19, v19, v83
    v_mfma_f32_16x16x32_bf16 v[56:59], a[36:39], v[116:119], 0
    v_cvt_pk_bf16_f32 v122, v16, v17
    v_cvt_pk_bf16_f32 v123, v18, v19
    v_mfma_f32_16x16x32_bf16 v[60:63], a[40:43], v[116:119], 0
    v_mfma_f32_16x16x32_bf16 v[64:67], a[44:47], v[116:119], 0
    s_waitcnt lgkmcnt(3)
    v_mfma_f32_16x16x32_bf16 v[20:23], a[48:51], v[120:123], v[20:23]
    v_lshlrev_b32 v12, 16, v124
    v_and_b32 v13, s31, v124
    v_mfma_f32_16x16x32_bf16 v[24:27], a[52:55], v[120:123], v[24:27]
    v_lshlrev_b32 v14, 16, v125
    v_and_b32 v15, s31, v125
    v_mfma_f32_16x16x32_bf16 v[28:31], a[56:59], v[120:123], v[28:31]
    v_mul_f32 v12, v12, v84
    v_mul_f32 v13, v13, v85
    v_mfma_f32_16x16x32_bf16 v[32:35], a[60:63], v[120:123], v[32:35]
    v_lshlrev_b32 v16, 16, v126
    v_and_b32 v17, s31, v126
    v_mfma_f32_16x16x32_bf16 v[36:39], a[64:67], v[120:123], v[36:39]
    v_mul_f32 v14, v14, v86
    v_mul_f32 v15, v15, v87
    v_mfma_f32_16x16x32_bf16 v[40:43], a[68:71], v[120:123], v[40:43]
    v_cvt_pk_bf16_f32 v124, v12, v13
    v_lshlrev_b32 v18, 16, v127
    v_mfma_f32_16x16x32_bf16 v[44:47], a[72:75], v[120:123], v[44:47]
    v_and_b32 v19, s31, v127
    v_mul_f32 v16, v16, v88
    v_mfma_f32_16x16x32_bf16 v[48:51], a[76:79], v[120:123], v[48:51]
    v_mul_f32 v17, v17, v89
    v_cvt_pk_bf16_f32 v125, v14, v15
    v_mfma_f32_16x16x32_bf16 v[52:55], a[80:83], v[120:123], v[52:55]
    v_mul_f32 v18, v18, v90
    v_mul_f32 v19, v19, v91
    v_mfma_f32_16x16x32_bf16 v[56:59], a[84:87], v[120:123], v[56:59]
    v_cvt_pk_bf16_f32 v126, v16, v17
    v_cvt_pk_bf16_f32 v127, v18, v19
    v_mfma_f32_16x16x32_bf16 v[60:63], a[88:91], v[120:123], v[60:63]
    v_mfma_f32_16x16x32_bf16 v[64:67], a[92:95], v[120:123], v[64:67]
    s_waitcnt lgkmcnt(2)
    v_mfma_f32_16x16x32_bf16 v[20:23], a[96:99], v[124:127], v[20:23]
    v_lshlrev_b32 v12, 16, v128
    v_and_b32 v13, s31, v128
    v_mfma_f32_16x16x32_bf16 v[24:27], a[100:103], v[124:127], v[24:27]
    v_lshlrev_b32 v14, 16, v129
    v_and_b32 v15, s31, v129
    v_mfma_f32_16x16x32_bf16 v[28:31], a[104:107], v[124:127], v[28:31]
    v_mul_f32 v12, v12, v92
    v_mul_f32 v13, v13, v93
    v_mfma_f32_16x16x32_bf16 v[32:35], a[108:111], v[124:127], v[32:35]
    v_lshlrev_b32 v16, 16, v130
    v_and_b32 v17, s31, v130
    v_mfma_f32_16x16x32_bf16 v[36:39], a[112:115], v[124:127], v[36:39]
    v_mul_f32 v14, v14, v94
    v_mul_f32 v15, v15, v95
    v_mfma_f32_16x16x32_bf16 v[40:43], a[116:119], v[124:127], v[40:43]
    v_cvt_pk_bf16_f32 v128, v12, v13
    v_lshlrev_b32 v18, 16, v131
    v_mfma_f32_16x16x32_bf16 v[44:47], a[120:123], v[124:127], v[44:47]
    v_and_b32 v19, s31, v131
    v_mul_f32 v16, v16, v96
    v_mfma_f32_16x16x32_bf16 v[48:51], a[124:127], v[124:127], v[48:51]
    v_mul_f32 v17, v17, v97
    v_cvt_pk_bf16_f32 v129, v14, v15
    v_mfma_f32_16x16x32_bf16 v[52:55], a[128:131], v[124:127], v[52:55]
    v_mul_f32 v18, v18, v98
    v_mul_f32 v19, v19, v99
    v_mfma_f32_16x16x32_bf16 v[56:59], a[132:135], v[124:127], v[56:59]
    v_cvt_pk_bf16_f32 v130, v16, v17
    v_cvt_pk_bf16_f32 v131, v18, v19
    v_mfma_f32_16x16x32_bf16 v[60:63], a[136:139], v[124:127], v[60:63]
    v_mfma_f32_16x16x32_bf16 v[64:67], a[140:143], v[124:127], v[64:67]
    s_waitcnt lgkmcnt(1)
    v_mfma_f32_16x16x32_bf16 v[20:23], a[144:147], v[128:131], v[20:23]
    v_lshlrev_b32 v12, 16, v132
    v_and_b32 v13, s31, v132
    v_mfma_f32_16x16x32_bf16 v[24:27], a[148:151], v[128:131], v[24:27]
    v_lshlrev_b32 v14, 16, v133
    v_and_b32 v15, s31, v133
    v_mfma_f32_16x16x32_bf16 v[28:31], a[152:155], v[128:131], v[28:31]
    v_mul_f32 v12, v12, v100
    v_mul_f32 v13, v13, v101
    v_mfma_f32_16x16x32_bf16 v[32:35], a[156:159], v[128:131], v[32:35]
    v_lshlrev_b32 v16, 16, v134
    v_and_b32 v17, s31, v134
    v_mfma_f32_16x16x32_bf16 v[36:39], a[160:163], v[128:131], v[36:39]
    v_mul_f32 v14, v14, v102
    v_mul_f32 v15, v15, v103
    v_mfma_f32_16x16x32_bf16 v[40:43], a[164:167], v[128:131], v[40:43]
    v_cvt_pk_bf16_f32 v132, v12, v13
    v_lshlrev_b32 v18, 16, v135
    v_mfma_f32_16x16x32_bf16 v[44:47], a[168:171], v[128:131], v[44:47]
    v_and_b32 v19, s31, v135
    v_mul_f32 v16, v16, v104
    v_mfma_f32_16x16x32_bf16 v[48:51], a[172:175], v[128:131], v[48:51]
    v_mul_f32 v17, v17, v105
    v_cvt_pk_bf16_f32 v133, v14, v15
    v_mfma_f32_16x16x32_bf16 v[52:55], a[176:179], v[128:131], v[52:55]
    v_mul_f32 v18, v18, v106
    v_mul_f32 v19, v19, v107
    v_mfma_f32_16x16x32_bf16 v[56:59], a[180:183], v[128:131], v[56:59]
    v_cvt_pk_bf16_f32 v134, v16, v17
    v_cvt_pk_bf16_f32 v135, v18, v19
    v_mfma_f32_16x16x32_bf16 v[60:63], a[184:187], v[128:131], v[60:63]
    v_mfma_f32_16x16x32_bf16 v[64:67], a[188:191], v[128:131], v[64:67]
    s_waitcnt lgkmcnt(0)
    v_mfma_f32_16x16x32_bf16 v[20:23], a[192:195], v[132:135], v[20:23]
    v_lshlrev_b32 v12, 16, v136
    v_and_b32 v13, s31, v136
    v_mfma_f32_16x16x32_bf16 v[24:27], a[196:199], v[132:135], v[24:27]
    v_lshlrev_b32 v14, 16, v137
    v_and_b32 v15, s31, v137
    v_mfma_f32_16x16x32_bf16 v[28:31], a[200:203], v[132:135], v[28:31]
    v_mul_f32 v12, v12, v108
    v_mul_f32 v13, v13, v109
    v_mfma_f32_16x16x32_bf16 v[32:35], a[204:207], v[132:135], v[32:35]
    v_lshlrev_b32 v16, 16, v138
    v_and_b32 v17, s31, v138
    v_mfma_f32_16x16x32_bf16 v[36:39], a[208:211], v[132:135], v[36:39]
    v_mul_f32 v14, v14, v110
    v_mul_f32 v15, v15, v111
    v_mfma_f32_16x16x32_bf16 v[40:43], a[212:215], v[132:135], v[40:43]
    v_cvt_pk_bf16_f32 v136, v12, v13
    v_lshlrev_b32 v18, 16, v139
    v_mfma_f32_16x16x32_bf16 v[44:47], a[216:219], v[132:135], v[44:47]
    v_and_b32 v19, s31, v139
    v_mul_f32 v16, v16, v112
    v_mfma_f32_16x16x32_bf16 v[48:51], a[220:223], v[132:135], v[48:51]
    v_mul_f32 v17, v17, v113
    v_cvt_pk_bf16_f32 v137, v14, v15
    v_mfma_f32_16x16x32_bf16 v[52:55], a[224:227], v[132:135], v[52:55]
    v_mul_f32 v18, v18, v114
    v_mul_f32 v19, v19, v115
    v_mfma_f32_16x16x32_bf16 v[56:59], a[228:231], v[132:135], v[56:59]
    v_cvt_pk_bf16_f32 v138, v16, v17
    v_cvt_pk_bf16_f32 v139, v18, v19
    v_mfma_f32_16x16x32_bf16 v[60:63], a[232:235], v[132:135], v[60:63]
    v_mfma_f32_16x16x32_bf16 v[64:67], a[236:239], v[132:135], v[64:67]
    v_mfma_f32_16x16x32_bf16 v[20:23], a[240:243], v[136:139], v[20:23]
    v_mfma_f32_16x16x32_bf16 v[24:27], a[244:247], v[136:139], v[24:27]
    v_mfma_f32_16x16x32_bf16 v[28:31], a[248:251], v[136:139], v[28:31]
    v_mfma_f32_16x16x32_bf16 v[32:35], a[252:255], v[136:139], v[32:35]
    v_mfma_f32_16x16x32_bf16 v[36:39], v[164:167], v[136:139], v[36:39]
    v_mfma_f32_16x16x32_bf16 v[40:43], v[168:171], v[136:139], v[40:43]
    v_mfma_f32_16x16x32_bf16 v[44:47], v[172:175], v[136:139], v[44:47]
    v_mfma_f32_16x16x32_bf16 v[48:51], v[176:179], v[136:139], v[48:51]
    v_mfma_f32_16x16x32_bf16 v[52:55], v[180:183], v[136:139], v[52:55]
    v_mfma_f32_16x16x32_bf16 v[56:59], v[184:187], v[136:139], v[56:59]
    v_mfma_f32_16x16x32_bf16 v[60:63], v[188:191], v[136:139], v[60:63]
    v_mfma_f32_16x16x32_bf16 v[64:67], v[192:195], v[136:139], v[64:67]
    v_cvt_pk_bf16_f32 v140, v20, v21
    v_cvt_pk_bf16_f32 v141, v22, v23
    v_cvt_pk_bf16_f32 v142, v24, v25
    v_cvt_pk_bf16_f32 v143, v26, v27
    ds_write_b64 v7, v[140:141] offset:0
    ds_write_b64 v8, v[142:143] offset:0
    v_cvt_pk_bf16_f32 v144, v28, v29
    v_cvt_pk_bf16_f32 v145, v30, v31
    v_cvt_pk_bf16_f32 v146, v32, v33
    v_cvt_pk_bf16_f32 v147, v34, v35
    ds_write_b64 v7, v[144:145] offset:64
    ds_write_b64 v8, v[146:147] offset:64
    v_cvt_pk_bf16_f32 v148, v36, v37
    v_cvt_pk_bf16_f32 v149, v38, v39
    v_cvt_pk_bf16_f32 v150, v40, v41
    v_cvt_pk_bf16_f32 v151, v42, v43
    ds_write_b64 v7, v[148:149] offset:128
    ds_write_b64 v8, v[150:151] offset:128
    v_cvt_pk_bf16_f32 v152, v44, v45
    v_cvt_pk_bf16_f32 v153, v46, v47
    v_cvt_pk_bf16_f32 v154, v48, v49
    v_cvt_pk_bf16_f32 v155, v50, v51
    ds_write_b64 v7, v[152:153] offset:192
    ds_write_b64 v8, v[154:155] offset:192
    v_cvt_pk_bf16_f32 v156, v52, v53
    v_cvt_pk_bf16_f32 v157, v54, v55
    v_cvt_pk_bf16_f32 v158, v56, v57
    v_cvt_pk_bf16_f32 v159, v58, v59
    ds_write_b64 v7, v[156:157] offset:256
    ds_write_b64 v8, v[158:159] offset:256
    v_cvt_pk_bf16_f32 v160, v60, v61
    v_cvt_pk_bf16_f32 v161, v62, v63
    v_cvt_pk_bf16_f32 v162, v64, v65
    v_cvt_pk_bf16_f32 v163, v66, v67
    ds_write_b64 v7, v[160:161] offset:320
    ds_write_b64 v8, v[162:163] offset:320
    ds_read_b128 v[140:143], v196 offset:0
    ds_read_b128 v[144:147], v197 offset:0
    ds_read_b128 v[148:151], v198 offset:0
    ds_read_b128 v[152:155], v196 offset:3200
    ds_read_b128 v[156:159], v197 offset:3200
    ds_read_b128 v[160:163], v198 offset:3200
    s_waitcnt vmcnt(12)
    v_readfirstlane_b32 s60, v11
    s_cmp_lg_u32 s50, 10
    s_cbranch_scc1 L_nf_b
    v_readfirstlane_b32 s34, v204
    s_nop 3
    s_and_b32 s34, s34, s61
    s_cselect_b32 s51, 13, 16
    s_cselect_b32 s56, 13, 0xffff
L_nf_b:
    s_mov_b64 exec, 1
    s_cmp_lg_u32 s50, 9
    s_cbranch_scc1 L_nl_b
    buffer_load_dword v204, v10, s[40:43], 0 offen sc0 sc1
L_nl_b:
    s_add_u32 s34, s50, 3
    s_cmp_ge_u32 s34, s56
    s_cselect_b32 s34, s57, 117440512
    v_mov_b32 v11, s71
    buffer_atomic_add v11, v10, s[44:47], s34 offen sc0
    s_mov_b64 exec, -1
    s_add_u32 s59, s50, 2
    s_lshr_b32 s34, s60, s70
    s_and_b32 s34, s34, 0xffff
    s_sub_u32 s35, 95, s34
    s_cmp_lt_u32 s34, 48
    s_waitcnt lgkmcnt(5)
    buffer_store_dwordx4 v[140:143], v1, s[16:19], s48 offen offset:0 sc1
    s_cselect_b32 s34, s34, s35
    s_cselect_b32 s35, s68, s69
    s_and_b32 s58, s34, 15
    s_add_u32 s35, s35, s58
    s_lshr_b32 s34, s34, 4
    s_waitcnt lgkmcnt(4)
    buffer_store_dwordx4 v[144:147], v1, s[16:19], s48 offen offset:1024 sc1
    s_add_u32 s34, s34, s51
    s_and_b32 s58, s60, 0xffff
    s_lshr_b32 s63, s60, 16
    s_add_u32 s58, s58, s63
    s_cmp_lt_u32 s58, 96
    s_waitcnt lgkmcnt(3)
    buffer_store_dwordx4 v[148:151], v1, s[16:19], s48 offen offset:2048 sc1
    s_cselect_b32 s34, s34, 16
    s_add_u32 s58, s30, s29
    s_cmp_lt_u32 s59, s51
    s_cselect_b32 s59, s59, s34
    s_cselect_b32 s35, s58, s35
    s_waitcnt lgkmcnt(2)
    buffer_store_dwordx4 v[152:155], v1, s[16:19], s48 offen offset:3072 sc1
    s_lshr_b32 s34, s59, 1
    s_lshl_b32 s34, s34, 11
    s_and_b32 s58, s59, 1
    s_lshl_b32 s58, s58, 7
    s_add_u32 s34, s34, s58
    s_waitcnt lgkmcnt(1)
    buffer_store_dwordx4 v[156:159], v2, s[16:19], s48 offen offset:0 sc1
    s_add_u32 s34, s34, s35
    s_mul_i32 s34, s34, 6144
    s_cmp_lt_u32 s59, 16
    s_cselect_b32 s58, s34, 117440512
    s_waitcnt lgkmcnt(0)
    buffer_store_dwordx4 v[160:163], v2, s[16:19], s48 offen offset:1024 sc1
    s_mov_b32 s48, s58
    s_add_u32 s50, s50, 1
    s_add_u32 m0, s33, 0
    s_nop 0
    buffer_load_dwordx4 v1, s[12:15], s48 offen offset:0 nt lds
    buffer_load_dwordx4 v1, s[12:15], s48 offen offset:1024 nt lds
    buffer_load_dwordx4 v1, s[12:15], s48 offen offset:2048 nt lds
    buffer_load_dwordx4 v1, s[12:15], s48 offen offset:3072 nt lds
    s_add_u32 m0, s33, 4096
    s_nop 0
    buffer_load_dwordx4 v2, s[12:15], s48 offen offset:0 nt lds
    buffer_load_dwordx4 v2, s[12:15], s48 offen offset:1024 nt lds
    s_branch L_loop
L_end:
L_done:
    s_endpgm
.section .rodata,"a"
.p2align 6
.amdhsa_kernel standalone__depthwise_separable__vision_kernel
  .amdhsa_next_free_vgpr 512
  .amdhsa_next_free_sgpr 80
  .amdhsa_accum_offset 256
  .amdhsa_group_segment_fixed_size 0
  .amdhsa_kernarg_size 48
  .amdhsa_user_sgpr_count 2
  .amdhsa_user_sgpr_kernarg_segment_ptr 1
  .amdhsa_system_sgpr_workgroup_id_x 1
  .amdhsa_float_denorm_mode_32 3
.end_amdhsa_kernel
```
